```python
import torch

def _softmax(x, axis=-1):
    return torch.softmax(x, dim=axis)
def _gelu(x):
    return torch.nn.functional.gelu(x, approximate="tanh")
def _silu(x):
    return torch.nn.functional.silu(x)
def _sigmoid(x):
    return torch.sigmoid(x)
def _layernorm(x, axis=-1, eps=1e-5):
    m = x.mean(dim=axis, keepdim=True)
    v = x.var(dim=axis, keepdim=True, unbiased=False)
    return (x - m) / torch.sqrt(v + eps)
def _scatter_add(tgt, idx, src, axis=0):
    return tgt.clone().index_add_(axis, idx, src)
def _segment_sum(src, seg, n):
    out = torch.zeros((n,) + src.shape[1:], dtype=src.dtype)
    return out.index_add_(0, seg, src)
def _pad(x, pw):
    flat = tuple(v for pair in reversed(pw) for v in pair)
    return torch.nn.functional.pad(x, flat)

kernel_name = 'parallel_sum__sliding_block_cached__mixer_channel_mlp__decode'

def setup_inputs():

    _w = (lambda a: (lambda t: t.to(torch.bfloat16) if t.is_floating_point() else t)(torch.as_tensor(a)))
    def _A_setup():
        B, Sq, D = 1, 1, 640
        Hq, Hkv, Sk, Dh = 32, 32, 4096, 128
        assert Hq % Hkv == 0, (Hq, Hkv)
        return {
            "x": _w((lambda *s: torch.randn(*s, dtype=torch.bfloat16) * 0.05)(B, Sq, D)),
            "k_cache": _w((lambda *s: torch.randn(*s, dtype=torch.bfloat16) * 3.2)(B, Hkv, Sk, Dh)),
            "v_cache": _w((lambda *s: torch.randn(*s, dtype=torch.bfloat16) * 0.4)(B, Hkv, Sk, Dh)),
            "wq": _w((lambda *s: torch.randn(*s, dtype=torch.bfloat16) * 3.2)(D, Hq * Dh) * (D ** -0.5)),
            "wo": _w((lambda *s: torch.randn(*s, dtype=torch.bfloat16) * 0.4)(Hq * Dh, D) * ((Hq * Dh) ** -0.5)),
        }
    _A_in = _A_setup()

    def _B_setup():
        B, S, D, F = 1, 1, 640, 1728
        return {
            "x": _w((lambda *s: torch.randn(*s, dtype=torch.bfloat16) * 0.05)(B, S, D)),
            "w1": _w((lambda *s: torch.randn(*s, dtype=torch.bfloat16) * 3.2)(D, F) * (D ** -0.5)),
            "b1": _w((lambda *s: torch.randn(*s, dtype=torch.bfloat16) * 0.8)(F)),
            "w2": _w((lambda *s: torch.randn(*s, dtype=torch.bfloat16) * 0.1)(F, D) * (F ** -0.5)),
            "b2": _w((lambda *s: torch.randn(*s, dtype=torch.bfloat16) * 0.1)(D)),
        }
    _B_in = _B_setup()

    return {
        "A_x": _A_in["x"],
        "A_k_cache": _A_in["k_cache"],
        "A_v_cache": _A_in["v_cache"],
        "A_wq": _A_in["wq"],
        "A_wo": _A_in["wo"],
        "B_x": _B_in["x"],
        "B_w1": _B_in["w1"],
        "B_b1": _B_in["b1"],
        "B_w2": _B_in["w2"],
        "B_b2": _B_in["b2"],
    }

def reference(A_x, A_k_cache, A_v_cache, A_wq, A_wo, B_x, B_w1, B_b1, B_w2, B_b2):
    def _A_ref(x, k_cache, v_cache, wq, wo):
        B, Sq, D = x.shape
        Hq, Dh = 32, 128
        Hkv, Sk = k_cache.shape[1], k_cache.shape[2]
        W = min(4096, max(256, Sk // 4))
        rep = Hq // Hkv
        q = (lambda x, *d: x.permute(*d))((x @ wq).reshape(B, Sq, Hq, Dh), 0, 2, 1, 3)
        k = (lambda x, n, axis: torch.repeat_interleave(x, n, dim=axis))(k_cache[:, :, Sk - W:, :], rep, axis=1)
        v = (lambda x, n, axis: torch.repeat_interleave(x, n, dim=axis))(v_cache[:, :, Sk - W:, :], rep, axis=1)
        scores = torch.einsum("bhqd,bhkd->bhqk", q, k) * (Dh ** -0.5)
        p = _softmax(scores, axis=-1)
        o = torch.einsum("bhqk,bhkd->bhqd", p, v)
        return (lambda x, *d: x.permute(*d))(o, 0, 2, 1, 3).reshape(B, Sq, Hq * Dh) @ wo

    def _B_ref(x, w1, b1, w2, b2):
        y = _layernorm(x, axis=-1)
        h = _gelu(torch.einsum("bsd,df->bsf", y, w1) + b1)
        return torch.einsum("bsf,fd->bsd", h, w2) + b2

    x = A_x
    xn = _layernorm(x, axis=-1)
    return x + _A_ref(xn, A_k_cache, A_v_cache, A_wq, A_wo) + _B_ref(xn, B_w1, B_b1, B_w2, B_b2)
```

```asm
; @launch grid=(256,1,1) block=(576,1,1) lds=65536
.amdgcn_target "amdgcn-amd-amdhsa--gfx950"
.text
.globl parallel_sum__sliding_block_cached__mixer_channel_mlp__decode_kernel
.p2align 8
.type parallel_sum__sliding_block_cached__mixer_channel_mlp__decode_kernel,@function
parallel_sum__sliding_block_cached__mixer_channel_mlp__decode_kernel:
s_cmp_ge_u32 s2, 256
s_cbranch_scc1 L_end
s_load_dwordx16 s[16:31], s[0:1], 0
s_load_dwordx8 s[32:39], s[0:1], 64
s_load_dwordx2 s[40:41], s[0:1], 96
s_and_b32 s3, s2, 31
s_lshr_b32 s4, s2, 5
v_lshrrev_b32 v1, 6, v0
s_nop 0
v_readfirstlane_b32 s5, v1
v_and_b32 v1, 63, v0
v_lshrrev_b32 v2, 4, v1
v_and_b32 v3, 15, v1
s_waitcnt lgkmcnt(0)
s_mov_b32 s44, s16
s_and_b32 s45, s17, 0xffff
s_mov_b32 s46, 1280
s_mov_b32 s47, 0x00020000
s_mov_b32 s56, s18
s_and_b32 s57, s19, 0xffff
s_mov_b32 s58, 33554432
s_mov_b32 s59, 0x00020000
s_mov_b32 s60, s20
s_and_b32 s61, s21, 0xffff
s_mov_b32 s62, 33554432
s_mov_b32 s63, 0x00020000
s_mov_b32 s48, s22
s_and_b32 s49, s23, 0xffff
s_mov_b32 s50, 5242880
s_mov_b32 s51, 0x00020000
s_mov_b32 s64, s24
s_and_b32 s65, s25, 0xffff
s_mov_b32 s66, 5242880
s_mov_b32 s67, 0x00020000
s_mov_b32 s52, s28
s_and_b32 s53, s29, 0xffff
s_mov_b32 s54, 2211840
s_mov_b32 s55, 0x00020000
s_mov_b32 s72, s30
s_and_b32 s73, s31, 0xffff
s_mov_b32 s74, 3456
s_mov_b32 s75, 0x00020000
s_mov_b32 s68, s32
s_and_b32 s69, s33, 0xffff
s_mov_b32 s70, 2211840
s_mov_b32 s71, 0x00020000
s_mov_b32 s76, s34
s_and_b32 s77, s35, 0xffff
s_mov_b32 s78, 1280
s_mov_b32 s79, 0x00020000
s_mov_b32 s80, s36
s_and_b32 s81, s37, 0xffff
s_mov_b32 s82, 1280
s_mov_b32 s83, 0x00020000
s_mov_b32 s84, s40
s_and_b32 s85, s41, 0xffff
s_mov_b32 s86, 268435456
s_mov_b32 s87, 0x00020000
s_cmp_eq_u32 s5, 8
s_cbranch_scc1 L_xwave
s_cmp_ge_u32 s5, 4
s_cbranch_scc1 L_awave
v_lshlrev_b32 v4, 2, v1
buffer_load_dword v10, v4, s[44:47], 0 offen offset:0
buffer_load_dword v11, v4, s[44:47], 0 offen offset:256
buffer_load_dword v12, v4, s[44:47], 0 offen offset:512
buffer_load_dword v13, v4, s[44:47], 0 offen offset:768
buffer_load_dword v14, v4, s[44:47], 0 offen offset:1024
s_mul_i32 s7, s4, 80
s_mul_i32 s8, s5, 20
s_add_u32 s7, s7, s8
v_add_u32 v5, s7, v2
v_lshlrev_b32 v6, 13, v5
v_lshl_add_u32 v6, v3, 4, v6
s_lshl_b32 s9, s3, 8
buffer_load_dwordx4 v[16:19], v6, s[48:51], s9 offen nt
s_add_u32 s9, s9, 32768
buffer_load_dwordx4 v[20:23], v6, s[48:51], s9 offen nt
s_add_u32 s9, s9, 32768
buffer_load_dwordx4 v[24:27], v6, s[48:51], s9 offen nt
s_add_u32 s9, s9, 32768
buffer_load_dwordx4 v[28:31], v6, s[48:51], s9 offen nt
s_add_u32 s9, s9, 32768
buffer_load_dwordx4 v[32:35], v6, s[48:51], s9 offen nt
v_mul_u32_u24 v7, 0xd80, v5
v_lshl_add_u32 v7, v3, 3, v7
s_lshl_b32 s9, s3, 7
buffer_load_dwordx2 v[36:37], v7, s[52:55], s9 offen nt
s_add_u32 s9, s9, 13824
buffer_load_dwordx2 v[38:39], v7, s[52:55], s9 offen nt
s_add_u32 s9, s9, 13824
buffer_load_dwordx2 v[40:41], v7, s[52:55], s9 offen nt
s_add_u32 s9, s9, 13824
buffer_load_dwordx2 v[42:43], v7, s[52:55], s9 offen nt
s_add_u32 s9, s9, 13824
buffer_load_dwordx2 v[44:45], v7, s[52:55], s9 offen nt
s_waitcnt vmcnt(10)
v_lshlrev_b32 v100, 16, v10
v_and_b32 v101, 0xffff0000, v10
v_lshlrev_b32 v102, 16, v11
v_and_b32 v103, 0xffff0000, v11
v_lshlrev_b32 v104, 16, v12
v_and_b32 v105, 0xffff0000, v12
v_lshlrev_b32 v106, 16, v13
v_and_b32 v107, 0xffff0000, v13
v_lshlrev_b32 v108, 16, v14
v_and_b32 v109, 0xffff0000, v14
v_add_f32 v130, v100, v101
v_add_f32 v130, v130, v102
v_add_f32 v130, v130, v103
v_add_f32 v130, v130, v104
v_add_f32 v130, v130, v105
v_add_f32 v130, v130, v106
v_add_f32 v130, v130, v107
v_add_f32 v130, v130, v108
v_add_f32 v130, v130, v109
v_mov_b32 v131, v130
s_nop 1
v_add_f32_dpp v131, v131, v131 row_shr:1 row_mask:0xf bank_mask:0xf bound_ctrl:0
s_nop 1
v_add_f32_dpp v131, v131, v131 row_shr:2 row_mask:0xf bank_mask:0xf bound_ctrl:0
s_nop 1
v_add_f32_dpp v131, v131, v131 row_shr:4 row_mask:0xf bank_mask:0xf bound_ctrl:0
s_nop 1
v_add_f32_dpp v131, v131, v131 row_shr:8 row_mask:0xf bank_mask:0xf bound_ctrl:0
s_nop 1
v_add_f32_dpp v131, v131, v131 row_bcast:15 row_mask:0xa bank_mask:0xf
s_nop 1
v_add_f32_dpp v131, v131, v131 row_bcast:31 row_mask:0xc bank_mask:0xf
s_nop 1
v_readlane_b32 s8, v131, 63
s_nop 1
v_mov_b32 v132, s8
v_mul_f32 v132, 0x3acccccd, v132
v_cvt_pk_bf16_f32 v133, v132, v132
v_lshlrev_b32 v133, 16, v133
v_sub_f32 v131, v100, v132
v_mul_f32 v130, v131, v131
v_sub_f32 v131, v101, v132
v_fmac_f32 v130, v131, v131
v_sub_f32 v131, v102, v132
v_fmac_f32 v130, v131, v131
v_sub_f32 v131, v103, v132
v_fmac_f32 v130, v131, v131
v_sub_f32 v131, v104, v132
v_fmac_f32 v130, v131, v131
v_sub_f32 v131, v105, v132
v_fmac_f32 v130, v131, v131
v_sub_f32 v131, v106, v132
v_fmac_f32 v130, v131, v131
v_sub_f32 v131, v107, v132
v_fmac_f32 v130, v131, v131
v_sub_f32 v131, v108, v132
v_fmac_f32 v130, v131, v131
v_sub_f32 v131, v109, v132
v_fmac_f32 v130, v131, v131
v_mov_b32 v131, v130
s_nop 1
v_add_f32_dpp v131, v131, v131 row_shr:1 row_mask:0xf bank_mask:0xf bound_ctrl:0
s_nop 1
v_add_f32_dpp v131, v131, v131 row_shr:2 row_mask:0xf bank_mask:0xf bound_ctrl:0
s_nop 1
v_add_f32_dpp v131, v131, v131 row_shr:4 row_mask:0xf bank_mask:0xf bound_ctrl:0
s_nop 1
v_add_f32_dpp v131, v131, v131 row_shr:8 row_mask:0xf bank_mask:0xf bound_ctrl:0
s_nop 1
v_add_f32_dpp v131, v131, v131 row_bcast:15 row_mask:0xa bank_mask:0xf
s_nop 1
v_add_f32_dpp v131, v131, v131 row_bcast:31 row_mask:0xc bank_mask:0xf
s_nop 1
v_readlane_b32 s8, v131, 63
s_nop 1
v_mov_b32 v134, s8
v_mul_f32 v134, 0x3acccccd, v134
v_cvt_pk_bf16_f32 v134, v134, v134
v_lshlrev_b32 v134, 16, v134
v_add_f32 v134, 0x3727c5ac, v134
v_cvt_pk_bf16_f32 v134, v134, v134
v_lshlrev_b32 v134, 16, v134
v_sqrt_f32 v134, v134
s_nop 0
v_cvt_pk_bf16_f32 v134, v134, v134
v_lshlrev_b32 v134, 16, v134
v_rcp_f32 v135, v134
s_nop 0
v_sub_f32 v130, v100, v133
v_cvt_pk_bf16_f32 v130, v130, v130
v_lshlrev_b32 v130, 16, v130
v_mul_f32 v131, v130, v135
v_fma_f32 v130, -v131, v134, v130
v_fmac_f32 v131, v130, v135
v_cvt_pk_bf16_f32 v110, v131, v131
v_lshlrev_b32 v110, 16, v110
v_sub_f32 v130, v101, v133
v_cvt_pk_bf16_f32 v130, v130, v130
v_lshlrev_b32 v130, 16, v130
v_mul_f32 v131, v130, v135
v_fma_f32 v130, -v131, v134, v130
v_fmac_f32 v131, v130, v135
v_cvt_pk_bf16_f32 v111, v131, v131
v_lshlrev_b32 v111, 16, v111
v_sub_f32 v130, v102, v133
v_cvt_pk_bf16_f32 v130, v130, v130
v_lshlrev_b32 v130, 16, v130
v_mul_f32 v131, v130, v135
v_fma_f32 v130, -v131, v134, v130
v_fmac_f32 v131, v130, v135
v_cvt_pk_bf16_f32 v112, v131, v131
v_lshlrev_b32 v112, 16, v112
v_sub_f32 v130, v103, v133
v_cvt_pk_bf16_f32 v130, v130, v130
v_lshlrev_b32 v130, 16, v130
v_mul_f32 v131, v130, v135
v_fma_f32 v130, -v131, v134, v130
v_fmac_f32 v131, v130, v135
v_cvt_pk_bf16_f32 v113, v131, v131
v_lshlrev_b32 v113, 16, v113
v_sub_f32 v130, v104, v133
v_cvt_pk_bf16_f32 v130, v130, v130
v_lshlrev_b32 v130, 16, v130
v_mul_f32 v131, v130, v135
v_fma_f32 v130, -v131, v134, v130
v_fmac_f32 v131, v130, v135
v_cvt_pk_bf16_f32 v114, v131, v131
v_lshlrev_b32 v114, 16, v114
v_sub_f32 v130, v105, v133
v_cvt_pk_bf16_f32 v130, v130, v130
v_lshlrev_b32 v130, 16, v130
v_mul_f32 v131, v130, v135
v_fma_f32 v130, -v131, v134, v130
v_fmac_f32 v131, v130, v135
v_cvt_pk_bf16_f32 v115, v131, v131
v_lshlrev_b32 v115, 16, v115
v_sub_f32 v130, v106, v133
v_cvt_pk_bf16_f32 v130, v130, v130
v_lshlrev_b32 v130, 16, v130
v_mul_f32 v131, v130, v135
v_fma_f32 v130, -v131, v134, v130
v_fmac_f32 v131, v130, v135
v_cvt_pk_bf16_f32 v116, v131, v131
v_lshlrev_b32 v116, 16, v116
v_sub_f32 v130, v107, v133
v_cvt_pk_bf16_f32 v130, v130, v130
v_lshlrev_b32 v130, 16, v130
v_mul_f32 v131, v130, v135
v_fma_f32 v130, -v131, v134, v130
v_fmac_f32 v131, v130, v135
v_cvt_pk_bf16_f32 v117, v131, v131
v_lshlrev_b32 v117, 16, v117
v_sub_f32 v130, v108, v133
v_cvt_pk_bf16_f32 v130, v130, v130
v_lshlrev_b32 v130, 16, v130
v_mul_f32 v131, v130, v135
v_fma_f32 v130, -v131, v134, v130
v_fmac_f32 v131, v130, v135
v_cvt_pk_bf16_f32 v118, v131, v131
v_lshlrev_b32 v118, 16, v118
v_sub_f32 v130, v109, v133
v_cvt_pk_bf16_f32 v130, v130, v130
v_lshlrev_b32 v130, 16, v130
v_mul_f32 v131, v130, v135
v_fma_f32 v130, -v131, v134, v130
v_fmac_f32 v131, v130, v135
v_cvt_pk_bf16_f32 v119, v131, v131
v_lshlrev_b32 v119, 16, v119
v_add_f32 v130, v110, v111
v_add_f32 v130, v130, v112
v_add_f32 v130, v130, v113
v_add_f32 v130, v130, v114
v_add_f32 v130, v130, v115
v_add_f32 v130, v130, v116
v_add_f32 v130, v130, v117
v_add_f32 v130, v130, v118
v_add_f32 v130, v130, v119
v_mov_b32 v131, v130
s_nop 1
v_add_f32_dpp v131, v131, v131 row_shr:1 row_mask:0xf bank_mask:0xf bound_ctrl:0
s_nop 1
v_add_f32_dpp v131, v131, v131 row_shr:2 row_mask:0xf bank_mask:0xf bound_ctrl:0
s_nop 1
v_add_f32_dpp v131, v131, v131 row_shr:4 row_mask:0xf bank_mask:0xf bound_ctrl:0
s_nop 1
v_add_f32_dpp v131, v131, v131 row_shr:8 row_mask:0xf bank_mask:0xf bound_ctrl:0
s_nop 1
v_add_f32_dpp v131, v131, v131 row_bcast:15 row_mask:0xa bank_mask:0xf
s_nop 1
v_add_f32_dpp v131, v131, v131 row_bcast:31 row_mask:0xc bank_mask:0xf
s_nop 1
v_readlane_b32 s8, v131, 63
s_nop 1
v_mov_b32 v132, s8
v_mul_f32 v132, 0x3acccccd, v132
v_cvt_pk_bf16_f32 v133, v132, v132
v_lshlrev_b32 v133, 16, v133
v_sub_f32 v131, v110, v132
v_mul_f32 v130, v131, v131
v_sub_f32 v131, v111, v132
v_fmac_f32 v130, v131, v131
v_sub_f32 v131, v112, v132
v_fmac_f32 v130, v131, v131
v_sub_f32 v131, v113, v132
v_fmac_f32 v130, v131, v131
v_sub_f32 v131, v114, v132
v_fmac_f32 v130, v131, v131
v_sub_f32 v131, v115, v132
v_fmac_f32 v130, v131, v131
v_sub_f32 v131, v116, v132
v_fmac_f32 v130, v131, v131
v_sub_f32 v131, v117, v132
v_fmac_f32 v130, v131, v131
v_sub_f32 v131, v118, v132
v_fmac_f32 v130, v131, v131
v_sub_f32 v131, v119, v132
v_fmac_f32 v130, v131, v131
v_mov_b32 v131, v130
s_nop 1
v_add_f32_dpp v131, v131, v131 row_shr:1 row_mask:0xf bank_mask:0xf bound_ctrl:0
s_nop 1
v_add_f32_dpp v131, v131, v131 row_shr:2 row_mask:0xf bank_mask:0xf bound_ctrl:0
s_nop 1
v_add_f32_dpp v131, v131, v131 row_shr:4 row_mask:0xf bank_mask:0xf bound_ctrl:0
s_nop 1
v_add_f32_dpp v131, v131, v131 row_shr:8 row_mask:0xf bank_mask:0xf bound_ctrl:0
s_nop 1
v_add_f32_dpp v131, v131, v131 row_bcast:15 row_mask:0xa bank_mask:0xf
s_nop 1
v_add_f32_dpp v131, v131, v131 row_bcast:31 row_mask:0xc bank_mask:0xf
s_nop 1
v_readlane_b32 s8, v131, 63
s_nop 1
v_mov_b32 v134, s8
v_mul_f32 v134, 0x3acccccd, v134
v_cvt_pk_bf16_f32 v134, v134, v134
v_lshlrev_b32 v134, 16, v134
v_add_f32 v134, 0x3727c5ac, v134
v_cvt_pk_bf16_f32 v134, v134, v134
v_lshlrev_b32 v134, 16, v134
v_sqrt_f32 v134, v134
s_nop 0
v_cvt_pk_bf16_f32 v134, v134, v134
v_lshlrev_b32 v134, 16, v134
v_rcp_f32 v135, v134
s_nop 0
v_sub_f32 v130, v110, v133
v_cvt_pk_bf16_f32 v130, v130, v130
v_lshlrev_b32 v130, 16, v130
v_mul_f32 v131, v130, v135
v_fma_f32 v130, -v131, v134, v130
v_fmac_f32 v131, v130, v135
v_cvt_pk_bf16_f32 v120, v131, v131
v_lshlrev_b32 v120, 16, v120
v_sub_f32 v130, v111, v133
v_cvt_pk_bf16_f32 v130, v130, v130
v_lshlrev_b32 v130, 16, v130
v_mul_f32 v131, v130, v135
v_fma_f32 v130, -v131, v134, v130
v_fmac_f32 v131, v130, v135
v_cvt_pk_bf16_f32 v121, v131, v131
v_lshlrev_b32 v121, 16, v121
v_sub_f32 v130, v112, v133
v_cvt_pk_bf16_f32 v130, v130, v130
v_lshlrev_b32 v130, 16, v130
v_mul_f32 v131, v130, v135
v_fma_f32 v130, -v131, v134, v130
v_fmac_f32 v131, v130, v135
v_cvt_pk_bf16_f32 v122, v131, v131
v_lshlrev_b32 v122, 16, v122
v_sub_f32 v130, v113, v133
v_cvt_pk_bf16_f32 v130, v130, v130
v_lshlrev_b32 v130, 16, v130
v_mul_f32 v131, v130, v135
v_fma_f32 v130, -v131, v134, v130
v_fmac_f32 v131, v130, v135
v_cvt_pk_bf16_f32 v123, v131, v131
v_lshlrev_b32 v123, 16, v123
v_sub_f32 v130, v114, v133
v_cvt_pk_bf16_f32 v130, v130, v130
v_lshlrev_b32 v130, 16, v130
v_mul_f32 v131, v130, v135
v_fma_f32 v130, -v131, v134, v130
v_fmac_f32 v131, v130, v135
v_cvt_pk_bf16_f32 v124, v131, v131
v_lshlrev_b32 v124, 16, v124
v_sub_f32 v130, v115, v133
v_cvt_pk_bf16_f32 v130, v130, v130
v_lshlrev_b32 v130, 16, v130
v_mul_f32 v131, v130, v135
v_fma_f32 v130, -v131, v134, v130
v_fmac_f32 v131, v130, v135
v_cvt_pk_bf16_f32 v125, v131, v131
v_lshlrev_b32 v125, 16, v125
v_sub_f32 v130, v116, v133
v_cvt_pk_bf16_f32 v130, v130, v130
v_lshlrev_b32 v130, 16, v130
v_mul_f32 v131, v130, v135
v_fma_f32 v130, -v131, v134, v130
v_fmac_f32 v131, v130, v135
v_cvt_pk_bf16_f32 v126, v131, v131
v_lshlrev_b32 v126, 16, v126
v_sub_f32 v130, v117, v133
v_cvt_pk_bf16_f32 v130, v130, v130
v_lshlrev_b32 v130, 16, v130
v_mul_f32 v131, v130, v135
v_fma_f32 v130, -v131, v134, v130
v_fmac_f32 v131, v130, v135
v_cvt_pk_bf16_f32 v127, v131, v131
v_lshlrev_b32 v127, 16, v127
v_sub_f32 v130, v118, v133
v_cvt_pk_bf16_f32 v130, v130, v130
v_lshlrev_b32 v130, 16, v130
v_mul_f32 v131, v130, v135
v_fma_f32 v130, -v131, v134, v130
v_fmac_f32 v131, v130, v135
v_cvt_pk_bf16_f32 v128, v131, v131
v_lshlrev_b32 v128, 16, v128
v_sub_f32 v130, v119, v133
v_cvt_pk_bf16_f32 v130, v130, v130
v_lshlrev_b32 v130, 16, v130
v_mul_f32 v131, v130, v135
v_fma_f32 v130, -v131, v134, v130
v_fmac_f32 v131, v130, v135
v_cvt_pk_bf16_f32 v129, v131, v131
v_lshlrev_b32 v129, 16, v129
s_mul_i32 s9, s5, 2560
v_lshlrev_b32 v9, 3, v1
v_add_u32 v9, s9, v9
ds_write_b64 v9, v[110:111] offset:0
ds_write_b64 v9, v[120:121] offset:10240
ds_write_b64 v9, v[112:113] offset:512
ds_write_b64 v9, v[122:123] offset:10752
ds_write_b64 v9, v[114:115] offset:1024
ds_write_b64 v9, v[124:125] offset:11264
ds_write_b64 v9, v[116:117] offset:1536
ds_write_b64 v9, v[126:127] offset:11776
ds_write_b64 v9, v[118:119] offset:2048
ds_write_b64 v9, v[128:129] offset:12288
v_lshlrev_b32 v9, 2, v5
v_add_u32 v9, s9, v9
s_waitcnt lgkmcnt(0)
ds_read_b32 v100, v9 offset:0
ds_read_b32 v105, v9 offset:10240
ds_read_b32 v101, v9 offset:16
ds_read_b32 v106, v9 offset:10256
ds_read_b32 v102, v9 offset:32
ds_read_b32 v107, v9 offset:10272
ds_read_b32 v103, v9 offset:48
ds_read_b32 v108, v9 offset:10288
ds_read_b32 v104, v9 offset:64
ds_read_b32 v109, v9 offset:10304
v_mov_b32 v110, 0
v_mov_b32 v111, 0
v_mov_b32 v112, 0
v_mov_b32 v113, 0
v_mov_b32 v114, 0
v_mov_b32 v115, 0
v_mov_b32 v116, 0
v_mov_b32 v117, 0
v_mov_b32 v118, 0
v_mov_b32 v119, 0
v_mov_b32 v120, 0
v_mov_b32 v121, 0
s_waitcnt vmcnt(0) lgkmcnt(0)
v_lshlrev_b32 v130, 16, v16
v_and_b32 v131, 0xffff0000, v16
v_fmac_f32 v110, v100, v130
v_fmac_f32 v111, v100, v131
v_lshlrev_b32 v130, 16, v17
v_and_b32 v131, 0xffff0000, v17
v_fmac_f32 v112, v100, v130
v_fmac_f32 v113, v100, v131
v_lshlrev_b32 v130, 16, v18
v_and_b32 v131, 0xffff0000, v18
v_fmac_f32 v114, v100, v130
v_fmac_f32 v115, v100, v131
v_lshlrev_b32 v130, 16, v19
v_and_b32 v131, 0xffff0000, v19
v_fmac_f32 v116, v100, v130
v_fmac_f32 v117, v100, v131
v_lshlrev_b32 v130, 16, v36
v_and_b32 v131, 0xffff0000, v36
v_fmac_f32 v118, v105, v130
v_fmac_f32 v119, v105, v131
v_lshlrev_b32 v130, 16, v37
v_and_b32 v131, 0xffff0000, v37
v_fmac_f32 v120, v105, v130
v_fmac_f32 v121, v105, v131
v_lshlrev_b32 v130, 16, v20
v_and_b32 v131, 0xffff0000, v20
v_fmac_f32 v110, v101, v130
v_fmac_f32 v111, v101, v131
v_lshlrev_b32 v130, 16, v21
v_and_b32 v131, 0xffff0000, v21
v_fmac_f32 v112, v101, v130
v_fmac_f32 v113, v101, v131
v_lshlrev_b32 v130, 16, v22
v_and_b32 v131, 0xffff0000, v22
v_fmac_f32 v114, v101, v130
v_fmac_f32 v115, v101, v131
v_lshlrev_b32 v130, 16, v23
v_and_b32 v131, 0xffff0000, v23
v_fmac_f32 v116, v101, v130
v_fmac_f32 v117, v101, v131
v_lshlrev_b32 v130, 16, v38
v_and_b32 v131, 0xffff0000, v38
v_fmac_f32 v118, v106, v130
v_fmac_f32 v119, v106, v131
v_lshlrev_b32 v130, 16, v39
v_and_b32 v131, 0xffff0000, v39
v_fmac_f32 v120, v106, v130
v_fmac_f32 v121, v106, v131
v_lshlrev_b32 v130, 16, v24
v_and_b32 v131, 0xffff0000, v24
v_fmac_f32 v110, v102, v130
v_fmac_f32 v111, v102, v131
v_lshlrev_b32 v130, 16, v25
v_and_b32 v131, 0xffff0000, v25
v_fmac_f32 v112, v102, v130
v_fmac_f32 v113, v102, v131
v_lshlrev_b32 v130, 16, v26
v_and_b32 v131, 0xffff0000, v26
v_fmac_f32 v114, v102, v130
v_fmac_f32 v115, v102, v131
v_lshlrev_b32 v130, 16, v27
v_and_b32 v131, 0xffff0000, v27
v_fmac_f32 v116, v102, v130
v_fmac_f32 v117, v102, v131
v_lshlrev_b32 v130, 16, v40
v_and_b32 v131, 0xffff0000, v40
v_fmac_f32 v118, v107, v130
v_fmac_f32 v119, v107, v131
v_lshlrev_b32 v130, 16, v41
v_and_b32 v131, 0xffff0000, v41
v_fmac_f32 v120, v107, v130
v_fmac_f32 v121, v107, v131
v_lshlrev_b32 v130, 16, v28
v_and_b32 v131, 0xffff0000, v28
v_fmac_f32 v110, v103, v130
v_fmac_f32 v111, v103, v131
v_lshlrev_b32 v130, 16, v29
v_and_b32 v131, 0xffff0000, v29
v_fmac_f32 v112, v103, v130
v_fmac_f32 v113, v103, v131
v_lshlrev_b32 v130, 16, v30
v_and_b32 v131, 0xffff0000, v30
v_fmac_f32 v114, v103, v130
v_fmac_f32 v115, v103, v131
v_lshlrev_b32 v130, 16, v31
v_and_b32 v131, 0xffff0000, v31
v_fmac_f32 v116, v103, v130
v_fmac_f32 v117, v103, v131
v_lshlrev_b32 v130, 16, v42
v_and_b32 v131, 0xffff0000, v42
v_fmac_f32 v118, v108, v130
v_fmac_f32 v119, v108, v131
v_lshlrev_b32 v130, 16, v43
v_and_b32 v131, 0xffff0000, v43
v_fmac_f32 v120, v108, v130
v_fmac_f32 v121, v108, v131
v_lshlrev_b32 v130, 16, v32
v_and_b32 v131, 0xffff0000, v32
v_fmac_f32 v110, v104, v130
v_fmac_f32 v111, v104, v131
v_lshlrev_b32 v130, 16, v33
v_and_b32 v131, 0xffff0000, v33
v_fmac_f32 v112, v104, v130
v_fmac_f32 v113, v104, v131
v_lshlrev_b32 v130, 16, v34
v_and_b32 v131, 0xffff0000, v34
v_fmac_f32 v114, v104, v130
v_fmac_f32 v115, v104, v131
v_lshlrev_b32 v130, 16, v35
v_and_b32 v131, 0xffff0000, v35
v_fmac_f32 v116, v104, v130
v_fmac_f32 v117, v104, v131
v_lshlrev_b32 v130, 16, v44
v_and_b32 v131, 0xffff0000, v44
v_fmac_f32 v118, v109, v130
v_fmac_f32 v119, v109, v131
v_lshlrev_b32 v130, 16, v45
v_and_b32 v131, 0xffff0000, v45
v_fmac_f32 v120, v109, v130
v_fmac_f32 v121, v109, v131
s_lshl_b32 s9, s5, 2
v_add_u32 v9, s9, v2
v_lshlrev_b32 v130, 9, v9
v_lshl_add_u32 v130, v3, 5, v130
ds_write_b128 v130, v[110:113] offset:20480
ds_write_b128 v130, v[114:117] offset:20496
v_lshlrev_b32 v131, 8, v9
v_lshl_add_u32 v131, v3, 4, v131
ds_write_b128 v131, v[118:121] offset:28672
s_waitcnt lgkmcnt(0)
s_barrier
v_mul_u32_u24 v88, 205, v1
v_lshrrev_b32 v88, 11, v88
v_mul_u32_u24 v89, 10, v88
v_sub_u32 v89, v1, v89
v_mov_b32 v90, 0x40000000
s_lshl_b32 s9, s5, 5
v_add_u32 v91, s9, v88
v_mul_u32_u24 v91, 0x500, v91
v_lshl_add_u32 v91, v89, 4, v91
v_cmp_gt_u32 vcc, 6, v88
s_nop 1
v_cndmask_b32 v92, v90, v91, vcc
v_cmp_gt_u32 vcc, 2, v88
s_nop 1
v_cndmask_b32 v93, v90, v91, vcc
s_mul_i32 s9, s3, 163840
s_mul_i32 s10, s4, 160
s_add_u32 s9, s9, s10
buffer_load_dwordx4 v[48:51], v92, s[64:67], s9 offen nt
s_add_u32 s9, s9, 7680
buffer_load_dwordx4 v[52:55], v92, s[64:67], s9 offen nt
s_add_u32 s9, s9, 7680
buffer_load_dwordx4 v[56:59], v92, s[64:67], s9 offen nt
s_add_u32 s9, s9, 7680
buffer_load_dwordx4 v[60:63], v92, s[64:67], s9 offen nt
s_add_u32 s9, s9, 7680
buffer_load_dwordx4 v[64:67], v92, s[64:67], s9 offen nt
s_add_u32 s9, s9, 7680
buffer_load_dwordx4 v[68:71], v93, s[64:67], s9 offen nt
s_lshl_b32 s9, s5, 4
v_add_u32 v91, s9, v88
v_mul_u32_u24 v91, 0x500, v91
v_lshl_add_u32 v91, v89, 4, v91
v_cmp_gt_u32 vcc, 6, v88
s_nop 1
v_cndmask_b32 v94, v90, v91, vcc
v_cmp_gt_u32 vcc, 4, v88
s_nop 1
v_cndmask_b32 v95, v90, v91, vcc
s_mul_i32 s9, s3, 81920
s_add_u32 s9, s9, s10
buffer_load_dwordx4 v[72:75], v94, s[68:71], s9 offen nt
s_add_u32 s9, s9, 7680
buffer_load_dwordx4 v[76:79], v94, s[68:71], s9 offen nt
s_add_u32 s9, s9, 7680
buffer_load_dwordx4 v[80:83], v95, s[68:71], s9 offen nt
s_barrier
s_barrier
s_barrier
s_lshl_b32 s9, s5, 5
v_add_u32 v9, s9, v88
v_lshlrev_b32 v9, 2, v9
ds_read_b32 v100, v9 offset:42304
ds_read_b32 v101, v9 offset:42328
ds_read_b32 v102, v9 offset:42352
ds_read_b32 v103, v9 offset:42376
ds_read_b32 v104, v9 offset:42400
ds_read_b32 v105, v9 offset:42424
s_lshl_b32 s9, s5, 4
v_add_u32 v9, s9, v88
v_lshlrev_b32 v9, 2, v9
ds_read_b32 v106, v9 offset:33024
ds_read_b32 v107, v9 offset:33048
ds_read_b32 v108, v9 offset:33072
v_mov_b32 v110, 0
v_mov_b32 v111, 0
v_mov_b32 v112, 0
v_mov_b32 v113, 0
v_mov_b32 v114, 0
v_mov_b32 v115, 0
v_mov_b32 v116, 0
v_mov_b32 v117, 0
v_mov_b32 v118, 0
v_mov_b32 v119, 0
v_mov_b32 v120, 0
v_mov_b32 v121, 0
v_mov_b32 v122, 0
v_mov_b32 v123, 0
v_mov_b32 v124, 0
v_mov_b32 v125, 0
s_waitcnt vmcnt(0) lgkmcnt(0)
v_lshlrev_b32 v130, 16, v48
v_and_b32 v131, 0xffff0000, v48
v_fmac_f32 v110, v100, v130
v_fmac_f32 v111, v100, v131
v_lshlrev_b32 v130, 16, v49
v_and_b32 v131, 0xffff0000, v49
v_fmac_f32 v112, v100, v130
v_fmac_f32 v113, v100, v131
v_lshlrev_b32 v130, 16, v50
v_and_b32 v131, 0xffff0000, v50
v_fmac_f32 v114, v100, v130
v_fmac_f32 v115, v100, v131
v_lshlrev_b32 v130, 16, v51
v_and_b32 v131, 0xffff0000, v51
v_fmac_f32 v116, v100, v130
v_fmac_f32 v117, v100, v131
v_lshlrev_b32 v130, 16, v52
v_and_b32 v131, 0xffff0000, v52
v_fmac_f32 v110, v101, v130
v_fmac_f32 v111, v101, v131
v_lshlrev_b32 v130, 16, v53
v_and_b32 v131, 0xffff0000, v53
v_fmac_f32 v112, v101, v130
v_fmac_f32 v113, v101, v131
v_lshlrev_b32 v130, 16, v54
v_and_b32 v131, 0xffff0000, v54
v_fmac_f32 v114, v101, v130
v_fmac_f32 v115, v101, v131
v_lshlrev_b32 v130, 16, v55
v_and_b32 v131, 0xffff0000, v55
v_fmac_f32 v116, v101, v130
v_fmac_f32 v117, v101, v131
v_lshlrev_b32 v130, 16, v56
v_and_b32 v131, 0xffff0000, v56
v_fmac_f32 v110, v102, v130
v_fmac_f32 v111, v102, v131
v_lshlrev_b32 v130, 16, v57
v_and_b32 v131, 0xffff0000, v57
v_fmac_f32 v112, v102, v130
v_fmac_f32 v113, v102, v131
v_lshlrev_b32 v130, 16, v58
v_and_b32 v131, 0xffff0000, v58
v_fmac_f32 v114, v102, v130
v_fmac_f32 v115, v102, v131
v_lshlrev_b32 v130, 16, v59
v_and_b32 v131, 0xffff0000, v59
v_fmac_f32 v116, v102, v130
v_fmac_f32 v117, v102, v131
v_lshlrev_b32 v130, 16, v60
v_and_b32 v131, 0xffff0000, v60
v_fmac_f32 v110, v103, v130
v_fmac_f32 v111, v103, v131
v_lshlrev_b32 v130, 16, v61
v_and_b32 v131, 0xffff0000, v61
v_fmac_f32 v112, v103, v130
v_fmac_f32 v113, v103, v131
v_lshlrev_b32 v130, 16, v62
v_and_b32 v131, 0xffff0000, v62
v_fmac_f32 v114, v103, v130
v_fmac_f32 v115, v103, v131
v_lshlrev_b32 v130, 16, v63
v_and_b32 v131, 0xffff0000, v63
v_fmac_f32 v116, v103, v130
v_fmac_f32 v117, v103, v131
v_lshlrev_b32 v130, 16, v64
v_and_b32 v131, 0xffff0000, v64
v_fmac_f32 v110, v104, v130
v_fmac_f32 v111, v104, v131
v_lshlrev_b32 v130, 16, v65
v_and_b32 v131, 0xffff0000, v65
v_fmac_f32 v112, v104, v130
v_fmac_f32 v113, v104, v131
v_lshlrev_b32 v130, 16, v66
v_and_b32 v131, 0xffff0000, v66
v_fmac_f32 v114, v104, v130
v_fmac_f32 v115, v104, v131
v_lshlrev_b32 v130, 16, v67
v_and_b32 v131, 0xffff0000, v67
v_fmac_f32 v116, v104, v130
v_fmac_f32 v117, v104, v131
v_lshlrev_b32 v130, 16, v68
v_and_b32 v131, 0xffff0000, v68
v_fmac_f32 v110, v105, v130
v_fmac_f32 v111, v105, v131
v_lshlrev_b32 v130, 16, v69
v_and_b32 v131, 0xffff0000, v69
v_fmac_f32 v112, v105, v130
v_fmac_f32 v113, v105, v131
v_lshlrev_b32 v130, 16, v70
v_and_b32 v131, 0xffff0000, v70
v_fmac_f32 v114, v105, v130
v_fmac_f32 v115, v105, v131
v_lshlrev_b32 v130, 16, v71
v_and_b32 v131, 0xffff0000, v71
v_fmac_f32 v116, v105, v130
v_fmac_f32 v117, v105, v131
v_lshlrev_b32 v130, 16, v72
v_and_b32 v131, 0xffff0000, v72
v_fmac_f32 v118, v106, v130
v_fmac_f32 v119, v106, v131
v_lshlrev_b32 v130, 16, v73
v_and_b32 v131, 0xffff0000, v73
v_fmac_f32 v120, v106, v130
v_fmac_f32 v121, v106, v131
v_lshlrev_b32 v130, 16, v74
v_and_b32 v131, 0xffff0000, v74
v_fmac_f32 v122, v106, v130
v_fmac_f32 v123, v106, v131
v_lshlrev_b32 v130, 16, v75
v_and_b32 v131, 0xffff0000, v75
v_fmac_f32 v124, v106, v130
v_fmac_f32 v125, v106, v131
v_lshlrev_b32 v130, 16, v76
v_and_b32 v131, 0xffff0000, v76
v_fmac_f32 v118, v107, v130
v_fmac_f32 v119, v107, v131
v_lshlrev_b32 v130, 16, v77
v_and_b32 v131, 0xffff0000, v77
v_fmac_f32 v120, v107, v130
v_fmac_f32 v121, v107, v131
v_lshlrev_b32 v130, 16, v78
v_and_b32 v131, 0xffff0000, v78
v_fmac_f32 v122, v107, v130
v_fmac_f32 v123, v107, v131
v_lshlrev_b32 v130, 16, v79
v_and_b32 v131, 0xffff0000, v79
v_fmac_f32 v124, v107, v130
v_fmac_f32 v125, v107, v131
v_lshlrev_b32 v130, 16, v80
v_and_b32 v131, 0xffff0000, v80
v_fmac_f32 v118, v108, v130
v_fmac_f32 v119, v108, v131
v_lshlrev_b32 v130, 16, v81
v_and_b32 v131, 0xffff0000, v81
v_fmac_f32 v120, v108, v130
v_fmac_f32 v121, v108, v131
v_lshlrev_b32 v130, 16, v82
v_and_b32 v131, 0xffff0000, v82
v_fmac_f32 v122, v108, v130
v_fmac_f32 v123, v108, v131
v_lshlrev_b32 v130, 16, v83
v_and_b32 v131, 0xffff0000, v83
v_fmac_f32 v124, v108, v130
v_fmac_f32 v125, v108, v131
s_mul_i32 s9, s5, 6
v_add_u32 v9, s9, v88
v_mul_u32_u24 v9, 320, v9
v_lshl_add_u32 v9, v89, 5, v9
v_cmp_gt_u32 vcc, 6, v88
s_and_saveexec_b64 s[12:13], vcc
ds_write_b128 v9, v[110:113] offset:43328
ds_write_b128 v9, v[114:117] offset:43344
ds_write_b128 v9, v[118:121] offset:51008
ds_write_b128 v9, v[122:125] offset:51024
s_mov_b64 exec, s[12:13]
s_waitcnt lgkmcnt(0)
s_barrier
s_branch L_end
L_awave:
s_sub_u32 s5, s5, 4
s_lshl_b32 s9, s5, 5
v_add_u32 v8, s9, v2
v_lshlrev_b32 v8, 8, v8
v_lshl_add_u32 v8, v3, 4, v8
s_lshl_b32 s9, s3, 20
s_lshl_b32 s10, s4, 15
s_add_u32 s9, s9, s10
s_add_u32 s9, s9, 786432
s_add_u32 s10, s9, 4096
buffer_load_dwordx4 v[16:19], v8, s[56:59], s9 offen offset:0 nt
buffer_load_dwordx4 v[20:23], v8, s[56:59], s9 offen offset:1024 nt
buffer_load_dwordx4 v[24:27], v8, s[56:59], s9 offen offset:2048 nt
buffer_load_dwordx4 v[28:31], v8, s[56:59], s9 offen offset:3072 nt
buffer_load_dwordx4 v[32:35], v8, s[56:59], s10 offen offset:0 nt
buffer_load_dwordx4 v[36:39], v8, s[56:59], s10 offen offset:1024 nt
buffer_load_dwordx4 v[40:43], v8, s[56:59], s10 offen offset:2048 nt
buffer_load_dwordx4 v[44:47], v8, s[56:59], s10 offen offset:3072 nt
buffer_load_dwordx4 v[48:51], v8, s[60:63], s9 offen offset:0 nt
buffer_load_dwordx4 v[52:55], v8, s[60:63], s9 offen offset:1024 nt
buffer_load_dwordx4 v[56:59], v8, s[60:63], s9 offen offset:2048 nt
buffer_load_dwordx4 v[60:63], v8, s[60:63], s9 offen offset:3072 nt
buffer_load_dwordx4 v[64:67], v8, s[60:63], s10 offen offset:0 nt
buffer_load_dwordx4 v[68:71], v8, s[60:63], s10 offen offset:1024 nt
buffer_load_dwordx4 v[72:75], v8, s[60:63], s10 offen offset:2048 nt
buffer_load_dwordx4 v[76:79], v8, s[60:63], s10 offen offset:3072 nt
s_barrier
s_barrier
v_lshlrev_b32 v9, 4, v3
ds_read_b128 v[100:103], v9 offset:32768
s_waitcnt vmcnt(8) lgkmcnt(0)
v_dot2_f32_bf16 v104, v16, v100, 0
v_dot2_f32_bf16 v105, v20, v100, 0
v_dot2_f32_bf16 v106, v24, v100, 0
v_dot2_f32_bf16 v107, v28, v100, 0
v_dot2_f32_bf16 v108, v32, v100, 0
v_dot2_f32_bf16 v109, v36, v100, 0
v_dot2_f32_bf16 v110, v40, v100, 0
v_dot2_f32_bf16 v111, v44, v100, 0
v_dot2_f32_bf16 v104, v17, v101, v104
v_dot2_f32_bf16 v105, v21, v101, v105
v_dot2_f32_bf16 v106, v25, v101, v106
v_dot2_f32_bf16 v107, v29, v101, v107
v_dot2_f32_bf16 v108, v33, v101, v108
v_dot2_f32_bf16 v109, v37, v101, v109
v_dot2_f32_bf16 v110, v41, v101, v110
v_dot2_f32_bf16 v111, v45, v101, v111
v_dot2_f32_bf16 v104, v18, v102, v104
v_dot2_f32_bf16 v105, v22, v102, v105
v_dot2_f32_bf16 v106, v26, v102, v106
v_dot2_f32_bf16 v107, v30, v102, v107
v_dot2_f32_bf16 v108, v34, v102, v108
v_dot2_f32_bf16 v109, v38, v102, v109
v_dot2_f32_bf16 v110, v42, v102, v110
v_dot2_f32_bf16 v111, v46, v102, v111
v_dot2_f32_bf16 v104, v19, v103, v104
v_dot2_f32_bf16 v105, v23, v103, v105
v_dot2_f32_bf16 v106, v27, v103, v106
v_dot2_f32_bf16 v107, v31, v103, v107
v_dot2_f32_bf16 v108, v35, v103, v108
v_dot2_f32_bf16 v109, v39, v103, v109
v_dot2_f32_bf16 v110, v43, v103, v110
v_dot2_f32_bf16 v111, v47, v103, v111
s_nop 2
v_add_f32_dpp v104, v104, v104 row_ror:8 row_mask:0xf bank_mask:0xf
v_add_f32_dpp v105, v105, v105 row_ror:8 row_mask:0xf bank_mask:0xf
v_add_f32_dpp v106, v106, v106 row_ror:8 row_mask:0xf bank_mask:0xf
v_add_f32_dpp v107, v107, v107 row_ror:8 row_mask:0xf bank_mask:0xf
v_add_f32_dpp v108, v108, v108 row_ror:8 row_mask:0xf bank_mask:0xf
v_add_f32_dpp v109, v109, v109 row_ror:8 row_mask:0xf bank_mask:0xf
v_add_f32_dpp v110, v110, v110 row_ror:8 row_mask:0xf bank_mask:0xf
v_add_f32_dpp v111, v111, v111 row_ror:8 row_mask:0xf bank_mask:0xf
v_add_f32_dpp v104, v104, v104 row_ror:4 row_mask:0xf bank_mask:0xf
v_add_f32_dpp v105, v105, v105 row_ror:4 row_mask:0xf bank_mask:0xf
v_add_f32_dpp v106, v106, v106 row_ror:4 row_mask:0xf bank_mask:0xf
v_add_f32_dpp v107, v107, v107 row_ror:4 row_mask:0xf bank_mask:0xf
v_add_f32_dpp v108, v108, v108 row_ror:4 row_mask:0xf bank_mask:0xf
v_add_f32_dpp v109, v109, v109 row_ror:4 row_mask:0xf bank_mask:0xf
v_add_f32_dpp v110, v110, v110 row_ror:4 row_mask:0xf bank_mask:0xf
v_add_f32_dpp v111, v111, v111 row_ror:4 row_mask:0xf bank_mask:0xf
v_add_f32_dpp v104, v104, v104 row_ror:2 row_mask:0xf bank_mask:0xf
v_add_f32_dpp v105, v105, v105 row_ror:2 row_mask:0xf bank_mask:0xf
v_add_f32_dpp v106, v106, v106 row_ror:2 row_mask:0xf bank_mask:0xf
v_add_f32_dpp v107, v107, v107 row_ror:2 row_mask:0xf bank_mask:0xf
v_add_f32_dpp v108, v108, v108 row_ror:2 row_mask:0xf bank_mask:0xf
v_add_f32_dpp v109, v109, v109 row_ror:2 row_mask:0xf bank_mask:0xf
v_add_f32_dpp v110, v110, v110 row_ror:2 row_mask:0xf bank_mask:0xf
v_add_f32_dpp v111, v111, v111 row_ror:2 row_mask:0xf bank_mask:0xf
v_add_f32_dpp v104, v104, v104 row_ror:1 row_mask:0xf bank_mask:0xf
v_add_f32_dpp v105, v105, v105 row_ror:1 row_mask:0xf bank_mask:0xf
v_add_f32_dpp v106, v106, v106 row_ror:1 row_mask:0xf bank_mask:0xf
v_add_f32_dpp v107, v107, v107 row_ror:1 row_mask:0xf bank_mask:0xf
v_add_f32_dpp v108, v108, v108 row_ror:1 row_mask:0xf bank_mask:0xf
v_add_f32_dpp v109, v109, v109 row_ror:1 row_mask:0xf bank_mask:0xf
v_add_f32_dpp v110, v110, v110 row_ror:1 row_mask:0xf bank_mask:0xf
v_add_f32_dpp v111, v111, v111 row_ror:1 row_mask:0xf bank_mask:0xf
s_nop 1
v_cvt_pk_bf16_f32 v104, v104, v104
v_lshlrev_b32 v104, 16, v104
v_cvt_pk_bf16_f32 v105, v105, v105
v_lshlrev_b32 v105, 16, v105
v_cvt_pk_bf16_f32 v106, v106, v106
v_lshlrev_b32 v106, 16, v106
v_cvt_pk_bf16_f32 v107, v107, v107
v_lshlrev_b32 v107, 16, v107
v_cvt_pk_bf16_f32 v108, v108, v108
v_lshlrev_b32 v108, 16, v108
v_cvt_pk_bf16_f32 v109, v109, v109
v_lshlrev_b32 v109, 16, v109
v_cvt_pk_bf16_f32 v110, v110, v110
v_lshlrev_b32 v110, 16, v110
v_cvt_pk_bf16_f32 v111, v111, v111
v_lshlrev_b32 v111, 16, v111
v_mul_f32 v104, 0x3db504f3, v104
v_mul_f32 v105, 0x3db504f3, v105
v_mul_f32 v106, 0x3db504f3, v106
v_mul_f32 v107, 0x3db504f3, v107
v_mul_f32 v108, 0x3db504f3, v108
v_mul_f32 v109, 0x3db504f3, v109
v_mul_f32 v110, 0x3db504f3, v110
v_mul_f32 v111, 0x3db504f3, v111
v_cvt_pk_bf16_f32 v104, v104, v104
v_lshlrev_b32 v104, 16, v104
v_cvt_pk_bf16_f32 v105, v105, v105
v_lshlrev_b32 v105, 16, v105
v_cvt_pk_bf16_f32 v106, v106, v106
v_lshlrev_b32 v106, 16, v106
v_cvt_pk_bf16_f32 v107, v107, v107
v_lshlrev_b32 v107, 16, v107
v_cvt_pk_bf16_f32 v108, v108, v108
v_lshlrev_b32 v108, 16, v108
v_cvt_pk_bf16_f32 v109, v109, v109
v_lshlrev_b32 v109, 16, v109
v_cvt_pk_bf16_f32 v110, v110, v110
v_lshlrev_b32 v110, 16, v110
v_cvt_pk_bf16_f32 v111, v111, v111
v_lshlrev_b32 v111, 16, v111
v_max3_f32 v112, v104, v105, v106
v_max3_f32 v113, v107, v108, v109
v_max3_f32 v112, v112, v110, v111
v_max_f32 v112, v112, v113
s_nop 1
v_readlane_b32 s8, v112, 0
v_readlane_b32 s9, v112, 16
v_readlane_b32 s10, v112, 32
v_readlane_b32 s11, v112, 48
s_nop 1
v_mov_b32 v112, s8
v_max_f32 v112, s9, v112
v_max_f32 v112, s10, v112
v_max_f32 v112, s11, v112
v_sub_f32 v104, v104, v112
v_sub_f32 v105, v105, v112
v_sub_f32 v106, v106, v112
v_sub_f32 v107, v107, v112
v_sub_f32 v108, v108, v112
v_sub_f32 v109, v109, v112
v_sub_f32 v110, v110, v112
v_sub_f32 v111, v111, v112
v_mul_f32 v104, 0x3fb8aa3b, v104
v_mul_f32 v105, 0x3fb8aa3b, v105
v_mul_f32 v106, 0x3fb8aa3b, v106
v_mul_f32 v107, 0x3fb8aa3b, v107
v_mul_f32 v108, 0x3fb8aa3b, v108
v_mul_f32 v109, 0x3fb8aa3b, v109
v_mul_f32 v110, 0x3fb8aa3b, v110
v_mul_f32 v111, 0x3fb8aa3b, v111
v_exp_f32 v104, v104
v_exp_f32 v105, v105
v_exp_f32 v106, v106
v_exp_f32 v107, v107
v_exp_f32 v108, v108
v_exp_f32 v109, v109
v_exp_f32 v110, v110
v_exp_f32 v111, v111
s_nop 0
v_add_f32 v113, v104, v105
v_add_f32 v113, v113, v106
v_add_f32 v113, v113, v107
v_add_f32 v113, v113, v108
v_add_f32 v113, v113, v109
v_add_f32 v113, v113, v110
v_add_f32 v113, v113, v111
s_nop 1
v_readlane_b32 s8, v113, 0
v_readlane_b32 s9, v113, 16
v_readlane_b32 s10, v113, 32
v_readlane_b32 s11, v113, 48
s_nop 1
v_mov_b32 v113, s8
v_add_f32 v113, s9, v113
v_add_f32 v113, s10, v113
v_add_f32 v113, s11, v113
v_mov_b32 v114, 0
v_mov_b32 v115, 0
v_mov_b32 v116, 0
v_mov_b32 v117, 0
v_mov_b32 v118, 0
v_mov_b32 v119, 0
v_mov_b32 v120, 0
v_mov_b32 v121, 0
s_waitcnt vmcnt(0)
v_lshlrev_b32 v130, 16, v48
v_and_b32 v131, 0xffff0000, v48
v_fmac_f32 v114, v104, v130
v_fmac_f32 v115, v104, v131
v_lshlrev_b32 v130, 16, v49
v_and_b32 v131, 0xffff0000, v49
v_fmac_f32 v116, v104, v130
v_fmac_f32 v117, v104, v131
v_lshlrev_b32 v130, 16, v50
v_and_b32 v131, 0xffff0000, v50
v_fmac_f32 v118, v104, v130
v_fmac_f32 v119, v104, v131
v_lshlrev_b32 v130, 16, v51
v_and_b32 v131, 0xffff0000, v51
v_fmac_f32 v120, v104, v130
v_fmac_f32 v121, v104, v131
v_lshlrev_b32 v130, 16, v52
v_and_b32 v131, 0xffff0000, v52
v_fmac_f32 v114, v105, v130
v_fmac_f32 v115, v105, v131
v_lshlrev_b32 v130, 16, v53
v_and_b32 v131, 0xffff0000, v53
v_fmac_f32 v116, v105, v130
v_fmac_f32 v117, v105, v131
v_lshlrev_b32 v130, 16, v54
v_and_b32 v131, 0xffff0000, v54
v_fmac_f32 v118, v105, v130
v_fmac_f32 v119, v105, v131
v_lshlrev_b32 v130, 16, v55
v_and_b32 v131, 0xffff0000, v55
v_fmac_f32 v120, v105, v130
v_fmac_f32 v121, v105, v131
v_lshlrev_b32 v130, 16, v56
v_and_b32 v131, 0xffff0000, v56
v_fmac_f32 v114, v106, v130
v_fmac_f32 v115, v106, v131
v_lshlrev_b32 v130, 16, v57
v_and_b32 v131, 0xffff0000, v57
v_fmac_f32 v116, v106, v130
v_fmac_f32 v117, v106, v131
v_lshlrev_b32 v130, 16, v58
v_and_b32 v131, 0xffff0000, v58
v_fmac_f32 v118, v106, v130
v_fmac_f32 v119, v106, v131
v_lshlrev_b32 v130, 16, v59
v_and_b32 v131, 0xffff0000, v59
v_fmac_f32 v120, v106, v130
v_fmac_f32 v121, v106, v131
v_lshlrev_b32 v130, 16, v60
v_and_b32 v131, 0xffff0000, v60
v_fmac_f32 v114, v107, v130
v_fmac_f32 v115, v107, v131
v_lshlrev_b32 v130, 16, v61
v_and_b32 v131, 0xffff0000, v61
v_fmac_f32 v116, v107, v130
v_fmac_f32 v117, v107, v131
v_lshlrev_b32 v130, 16, v62
v_and_b32 v131, 0xffff0000, v62
v_fmac_f32 v118, v107, v130
v_fmac_f32 v119, v107, v131
v_lshlrev_b32 v130, 16, v63
v_and_b32 v131, 0xffff0000, v63
v_fmac_f32 v120, v107, v130
v_fmac_f32 v121, v107, v131
v_lshlrev_b32 v130, 16, v64
v_and_b32 v131, 0xffff0000, v64
v_fmac_f32 v114, v108, v130
v_fmac_f32 v115, v108, v131
v_lshlrev_b32 v130, 16, v65
v_and_b32 v131, 0xffff0000, v65
v_fmac_f32 v116, v108, v130
v_fmac_f32 v117, v108, v131
v_lshlrev_b32 v130, 16, v66
v_and_b32 v131, 0xffff0000, v66
v_fmac_f32 v118, v108, v130
v_fmac_f32 v119, v108, v131
v_lshlrev_b32 v130, 16, v67
v_and_b32 v131, 0xffff0000, v67
v_fmac_f32 v120, v108, v130
v_fmac_f32 v121, v108, v131
v_lshlrev_b32 v130, 16, v68
v_and_b32 v131, 0xffff0000, v68
v_fmac_f32 v114, v109, v130
v_fmac_f32 v115, v109, v131
v_lshlrev_b32 v130, 16, v69
v_and_b32 v131, 0xffff0000, v69
v_fmac_f32 v116, v109, v130
v_fmac_f32 v117, v109, v131
v_lshlrev_b32 v130, 16, v70
v_and_b32 v131, 0xffff0000, v70
v_fmac_f32 v118, v109, v130
v_fmac_f32 v119, v109, v131
v_lshlrev_b32 v130, 16, v71
v_and_b32 v131, 0xffff0000, v71
v_fmac_f32 v120, v109, v130
v_fmac_f32 v121, v109, v131
v_lshlrev_b32 v130, 16, v72
v_and_b32 v131, 0xffff0000, v72
v_fmac_f32 v114, v110, v130
v_fmac_f32 v115, v110, v131
v_lshlrev_b32 v130, 16, v73
v_and_b32 v131, 0xffff0000, v73
v_fmac_f32 v116, v110, v130
v_fmac_f32 v117, v110, v131
v_lshlrev_b32 v130, 16, v74
v_and_b32 v131, 0xffff0000, v74
v_fmac_f32 v118, v110, v130
v_fmac_f32 v119, v110, v131
v_lshlrev_b32 v130, 16, v75
v_and_b32 v131, 0xffff0000, v75
v_fmac_f32 v120, v110, v130
v_fmac_f32 v121, v110, v131
v_lshlrev_b32 v130, 16, v76
v_and_b32 v131, 0xffff0000, v76
v_fmac_f32 v114, v111, v130
v_fmac_f32 v115, v111, v131
v_lshlrev_b32 v130, 16, v77
v_and_b32 v131, 0xffff0000, v77
v_fmac_f32 v116, v111, v130
v_fmac_f32 v117, v111, v131
v_lshlrev_b32 v130, 16, v78
v_and_b32 v131, 0xffff0000, v78
v_fmac_f32 v118, v111, v130
v_fmac_f32 v119, v111, v131
v_lshlrev_b32 v130, 16, v79
v_and_b32 v131, 0xffff0000, v79
v_fmac_f32 v120, v111, v130
v_fmac_f32 v121, v111, v131
s_lshl_b32 s9, s5, 2
v_add_u32 v9, s9, v2
v_lshlrev_b32 v130, 9, v9
v_lshl_add_u32 v130, v3, 5, v130
ds_write_b128 v130, v[114:117] offset:34112
ds_write_b128 v130, v[118:121] offset:34128
s_lshl_b32 s9, s5, 3
v_mov_b32 v9, s9
ds_write_b64 v9, v[112:113] offset:34048
s_waitcnt lgkmcnt(0)
s_barrier
s_barrier
s_barrier
s_branch L_end
L_xwave:
v_mov_b32 v4, 0
buffer_load_dword v10, v4, s[84:87], 0 offen offset:0 sc1
v_and_b32 v5, 31, v1
s_lshl_b32 s9, s3, 7
v_lshlrev_b32 v6, 2, v5
buffer_load_dword v11, v6, s[72:75], s9 offen
v_mul_u32_u24 v12, 205, v1
v_lshrrev_b32 v12, 11, v12
v_mul_u32_u24 v13, 10, v12
v_sub_u32 v13, v1, v13
s_mul_i32 s9, s4, 80
s_mul_i32 s10, s3, 20
s_add_u32 s9, s9, s10
s_lshl_b32 s14, s9, 1
v_lshlrev_b32 v14, 2, v13
buffer_load_dword v15, v14, s[44:47], s14 offen
buffer_load_dword v16, v14, s[76:79], s14 offen
s_waitcnt vmcnt(3)
v_add_u32 v10, 1, v10
s_nop 0
v_readfirstlane_b32 s6, v10
s_lshl_b32 s9, s3, 3
s_add_u32 s10, s9, s4
s_mul_i32 s11, s10, 1536
s_add_u32 s11, s11, 4096
s_mul_i32 s15, s9, 1536
s_add_u32 s15, s15, 4096
v_lshlrev_b32 v17, 4, v1
v_lshlrev_b32 v18, 4, v5
s_barrier
v_lshlrev_b32 v19, 3, v1
v_lshlrev_b32 v20, 3, v5
ds_read_b64 v[32:33], v19 offset:20480
ds_read_b64 v[64:65], v20 offset:28672
ds_read_b64 v[34:35], v19 offset:20992
ds_read_b64 v[66:67], v20 offset:28928
ds_read_b64 v[36:37], v19 offset:21504
ds_read_b64 v[68:69], v20 offset:29184
ds_read_b64 v[38:39], v19 offset:22016
ds_read_b64 v[70:71], v20 offset:29440
ds_read_b64 v[40:41], v19 offset:22528
ds_read_b64 v[72:73], v20 offset:29696
ds_read_b64 v[42:43], v19 offset:23040
ds_read_b64 v[74:75], v20 offset:29952
ds_read_b64 v[44:45], v19 offset:23552
ds_read_b64 v[76:77], v20 offset:30208
ds_read_b64 v[46:47], v19 offset:24064
ds_read_b64 v[78:79], v20 offset:30464
ds_read_b64 v[48:49], v19 offset:24576
ds_read_b64 v[80:81], v20 offset:30720
ds_read_b64 v[50:51], v19 offset:25088
ds_read_b64 v[82:83], v20 offset:30976
ds_read_b64 v[52:53], v19 offset:25600
ds_read_b64 v[84:85], v20 offset:31232
ds_read_b64 v[54:55], v19 offset:26112
ds_read_b64 v[86:87], v20 offset:31488
ds_read_b64 v[56:57], v19 offset:26624
ds_read_b64 v[88:89], v20 offset:31744
ds_read_b64 v[58:59], v19 offset:27136
ds_read_b64 v[90:91], v20 offset:32000
ds_read_b64 v[60:61], v19 offset:27648
ds_read_b64 v[92:93], v20 offset:32256
ds_read_b64 v[62:63], v19 offset:28160
ds_read_b64 v[94:95], v20 offset:32512
s_waitcnt lgkmcnt(0)
v_add_f32 v32, v32, v34
v_add_f32 v33, v33, v35
v_add_f32 v32, v32, v36
v_add_f32 v33, v33, v37
v_add_f32 v32, v32, v38
v_add_f32 v33, v33, v39
v_add_f32 v32, v32, v40
v_add_f32 v33, v33, v41
v_add_f32 v32, v32, v42
v_add_f32 v33, v33, v43
v_add_f32 v32, v32, v44
v_add_f32 v33, v33, v45
v_add_f32 v32, v32, v46
v_add_f32 v33, v33, v47
v_add_f32 v32, v32, v48
v_add_f32 v33, v33, v49
v_add_f32 v32, v32, v50
v_add_f32 v33, v33, v51
v_add_f32 v32, v32, v52
v_add_f32 v33, v33, v53
v_add_f32 v32, v32, v54
v_add_f32 v33, v33, v55
v_add_f32 v32, v32, v56
v_add_f32 v33, v33, v57
v_add_f32 v32, v32, v58
v_add_f32 v33, v33, v59
v_add_f32 v32, v32, v60
v_add_f32 v33, v33, v61
v_add_f32 v32, v32, v62
v_add_f32 v33, v33, v63
v_add_f32 v64, v64, v66
v_add_f32 v65, v65, v67
v_add_f32 v64, v64, v68
v_add_f32 v65, v65, v69
v_add_f32 v64, v64, v70
v_add_f32 v65, v65, v71
v_add_f32 v64, v64, v72
v_add_f32 v65, v65, v73
v_add_f32 v64, v64, v74
v_add_f32 v65, v65, v75
v_add_f32 v64, v64, v76
v_add_f32 v65, v65, v77
v_add_f32 v64, v64, v78
v_add_f32 v65, v65, v79
v_add_f32 v64, v64, v80
v_add_f32 v65, v65, v81
v_add_f32 v64, v64, v82
v_add_f32 v65, v65, v83
v_add_f32 v64, v64, v84
v_add_f32 v65, v65, v85
v_add_f32 v64, v64, v86
v_add_f32 v65, v65, v87
v_add_f32 v64, v64, v88
v_add_f32 v65, v65, v89
v_add_f32 v64, v64, v90
v_add_f32 v65, v65, v91
v_add_f32 v64, v64, v92
v_add_f32 v65, v65, v93
v_add_f32 v64, v64, v94
v_add_f32 v65, v65, v95
v_mov_b32 v24, v32
v_mov_b32 v25, v10
v_mov_b32 v26, v33
v_mov_b32 v27, v10
buffer_store_dwordx4 v[24:27], v17, s[84:87], s11 offen sc1
v_mov_b32 v28, v64
v_mov_b32 v29, v10
v_mov_b32 v30, v65
v_mov_b32 v31, v10
buffer_store_dwordx4 v[28:31], v18, s[84:87], s11 offen offset:1024 sc1
s_mov_b32 s12, 0
L_gq:
s_add_u32 s13, s15, 0
buffer_load_dwordx4 v[32:35], v17, s[84:87], s13 offen sc1
buffer_load_dwordx4 v[64:67], v18, s[84:87], s13 offen offset:1024 sc1
s_add_u32 s13, s15, 1536
buffer_load_dwordx4 v[36:39], v17, s[84:87], s13 offen sc1
buffer_load_dwordx4 v[68:71], v18, s[84:87], s13 offen offset:1024 sc1
s_add_u32 s13, s15, 3072
buffer_load_dwordx4 v[40:43], v17, s[84:87], s13 offen sc1
buffer_load_dwordx4 v[72:75], v18, s[84:87], s13 offen offset:1024 sc1
s_add_u32 s13, s15, 4608
buffer_load_dwordx4 v[44:47], v17, s[84:87], s13 offen sc1
buffer_load_dwordx4 v[76:79], v18, s[84:87], s13 offen offset:1024 sc1
s_add_u32 s13, s15, 6144
buffer_load_dwordx4 v[48:51], v17, s[84:87], s13 offen sc1
buffer_load_dwordx4 v[80:83], v18, s[84:87], s13 offen offset:1024 sc1
s_add_u32 s13, s15, 7680
buffer_load_dwordx4 v[52:55], v17, s[84:87], s13 offen sc1
buffer_load_dwordx4 v[84:87], v18, s[84:87], s13 offen offset:1024 sc1
s_add_u32 s13, s15, 9216
buffer_load_dwordx4 v[56:59], v17, s[84:87], s13 offen sc1
buffer_load_dwordx4 v[88:91], v18, s[84:87], s13 offen offset:1024 sc1
s_add_u32 s13, s15, 10752
buffer_load_dwordx4 v[60:63], v17, s[84:87], s13 offen sc1
buffer_load_dwordx4 v[92:95], v18, s[84:87], s13 offen offset:1024 sc1
s_waitcnt vmcnt(0)
v_mov_b32 v24, 0
v_xor_b32 v25, v10, v33
v_xor_b32 v26, v10, v35
v_or3_b32 v24, v24, v25, v26
v_xor_b32 v25, v10, v65
v_xor_b32 v26, v10, v67
v_or3_b32 v24, v24, v25, v26
v_xor_b32 v25, v10, v37
v_xor_b32 v26, v10, v39
v_or3_b32 v24, v24, v25, v26
v_xor_b32 v25, v10, v69
v_xor_b32 v26, v10, v71
v_or3_b32 v24, v24, v25, v26
v_xor_b32 v25, v10, v41
v_xor_b32 v26, v10, v43
v_or3_b32 v24, v24, v25, v26
v_xor_b32 v25, v10, v73
v_xor_b32 v26, v10, v75
v_or3_b32 v24, v24, v25, v26
v_xor_b32 v25, v10, v45
v_xor_b32 v26, v10, v47
v_or3_b32 v24, v24, v25, v26
v_xor_b32 v25, v10, v77
v_xor_b32 v26, v10, v79
v_or3_b32 v24, v24, v25, v26
v_xor_b32 v25, v10, v49
v_xor_b32 v26, v10, v51
v_or3_b32 v24, v24, v25, v26
v_xor_b32 v25, v10, v81
v_xor_b32 v26, v10, v83
v_or3_b32 v24, v24, v25, v26
v_xor_b32 v25, v10, v53
v_xor_b32 v26, v10, v55
v_or3_b32 v24, v24, v25, v26
v_xor_b32 v25, v10, v85
v_xor_b32 v26, v10, v87
v_or3_b32 v24, v24, v25, v26
v_xor_b32 v25, v10, v57
v_xor_b32 v26, v10, v59
v_or3_b32 v24, v24, v25, v26
v_xor_b32 v25, v10, v89
v_xor_b32 v26, v10, v91
v_or3_b32 v24, v24, v25, v26
v_xor_b32 v25, v10, v61
v_xor_b32 v26, v10, v63
v_or3_b32 v24, v24, v25, v26
v_xor_b32 v25, v10, v93
v_xor_b32 v26, v10, v95
v_or3_b32 v24, v24, v25, v26
v_cmp_ne_u32 vcc, 0, v24
s_add_u32 s12, s12, 1
s_cmp_gt_u32 s12, 200000
s_cbranch_scc1 L_gq_done
s_cbranch_vccnz L_gq
L_gq_done:
v_add_f32 v32, v32, v36
v_add_f32 v34, v34, v38
v_add_f32 v32, v32, v40
v_add_f32 v34, v34, v42
v_add_f32 v32, v32, v44
v_add_f32 v34, v34, v46
v_add_f32 v32, v32, v48
v_add_f32 v34, v34, v50
v_add_f32 v32, v32, v52
v_add_f32 v34, v34, v54
v_add_f32 v32, v32, v56
v_add_f32 v34, v34, v58
v_add_f32 v32, v32, v60
v_add_f32 v34, v34, v62
v_add_f32 v64, v64, v68
v_add_f32 v66, v66, v70
v_add_f32 v64, v64, v72
v_add_f32 v66, v66, v74
v_add_f32 v64, v64, v76
v_add_f32 v66, v66, v78
v_add_f32 v64, v64, v80
v_add_f32 v66, v66, v82
v_add_f32 v64, v64, v84
v_add_f32 v66, v66, v86
v_add_f32 v64, v64, v88
v_add_f32 v66, v66, v90
v_add_f32 v64, v64, v92
v_add_f32 v66, v66, v94
v_cvt_pk_bf16_f32 v24, v32, v34
v_lshlrev_b32 v25, 2, v1
ds_write_b32 v25, v24 offset:32768
v_lshlrev_b32 v26, 16, v11
v_and_b32 v27, 0xffff0000, v11
v_cvt_pk_bf16_f32 v64, v64, v64
v_lshlrev_b32 v64, 16, v64
v_add_f32 v64, v64, v26
v_cvt_pk_bf16_f32 v64, v64, v64
v_lshlrev_b32 v64, 16, v64
v_mul_f32 v28, v64, v64
v_mul_f32 v28, v28, v64
v_mov_b32 v29, 0x3d372713
v_fma_f32 v28, v28, v29, v64
v_mul_f32 v28, 0x3f4c422a, v28
v_mul_f32 v28, 0x4038aa3b, v28
v_exp_f32 v28, v28
s_nop 0
v_add_f32 v28, 1.0, v28
v_rcp_f32 v28, v28
s_nop 0
v_sub_f32 v28, 1.0, v28
v_mul_f32 v64, v64, v28
v_cvt_pk_bf16_f32 v64, v64, v64
v_lshlrev_b32 v64, 16, v64
v_cvt_pk_bf16_f32 v66, v66, v66
v_lshlrev_b32 v66, 16, v66
v_add_f32 v66, v66, v27
v_cvt_pk_bf16_f32 v66, v66, v66
v_lshlrev_b32 v66, 16, v66
v_mul_f32 v28, v66, v66
v_mul_f32 v28, v28, v66
v_mov_b32 v29, 0x3d372713
v_fma_f32 v28, v28, v29, v66
v_mul_f32 v28, 0x3f4c422a, v28
v_mul_f32 v28, 0x4038aa3b, v28
v_exp_f32 v28, v28
s_nop 0
v_add_f32 v28, 1.0, v28
v_rcp_f32 v28, v28
s_nop 0
v_sub_f32 v28, 1.0, v28
v_mul_f32 v66, v66, v28
v_cvt_pk_bf16_f32 v66, v66, v66
v_lshlrev_b32 v66, 16, v66
v_mov_b32 v65, v66
ds_write_b64 v20, v[64:65] offset:33024
v_mov_b32 v28, 0
v_mov_b32 v29, 0
ds_write_b64 v19, v[28:29] offset:33280
ds_write_b64 v19, v[28:29] offset:42816
s_waitcnt lgkmcnt(0)
s_barrier
s_barrier
v_mov_b32 v24, 0
ds_read_b128 v[96:99], v24 offset:34048
ds_read_b128 v[100:103], v24 offset:34064
ds_read_b64 v[32:33], v19 offset:34112
ds_read_b64 v[34:35], v19 offset:34624
ds_read_b64 v[36:37], v19 offset:35136
ds_read_b64 v[38:39], v19 offset:35648
ds_read_b64 v[40:41], v19 offset:36160
ds_read_b64 v[42:43], v19 offset:36672
ds_read_b64 v[44:45], v19 offset:37184
ds_read_b64 v[46:47], v19 offset:37696
ds_read_b64 v[48:49], v19 offset:38208
ds_read_b64 v[50:51], v19 offset:38720
ds_read_b64 v[52:53], v19 offset:39232
ds_read_b64 v[54:55], v19 offset:39744
ds_read_b64 v[56:57], v19 offset:40256
ds_read_b64 v[58:59], v19 offset:40768
ds_read_b64 v[60:61], v19 offset:41280
ds_read_b64 v[62:63], v19 offset:41792
s_waitcnt lgkmcnt(0)
v_max3_f32 v104, v96, v98, v100
v_max_f32 v104, v104, v102
v_sub_f32 v108, v96, v104
v_mul_f32 v108, 0x3fb8aa3b, v108
v_exp_f32 v108, v108
v_sub_f32 v109, v98, v104
v_mul_f32 v109, 0x3fb8aa3b, v109
v_exp_f32 v109, v109
v_sub_f32 v110, v100, v104
v_mul_f32 v110, 0x3fb8aa3b, v110
v_exp_f32 v110, v110
v_sub_f32 v111, v102, v104
v_mul_f32 v111, 0x3fb8aa3b, v111
v_exp_f32 v111, v111
s_nop 0
v_mul_f32 v105, v108, v97
v_fmac_f32 v105, v109, v99
v_fmac_f32 v105, v110, v101
v_fmac_f32 v105, v111, v103
v_mov_b32 v24, 0
v_mov_b32 v26, 0
v_add_f32 v32, v32, v34
v_add_f32 v33, v33, v35
v_add_f32 v36, v36, v38
v_add_f32 v37, v37, v39
v_add_f32 v32, v32, v36
v_add_f32 v33, v33, v37
v_fmac_f32 v24, v108, v32
v_fmac_f32 v26, v108, v33
v_add_f32 v40, v40, v42
v_add_f32 v41, v41, v43
v_add_f32 v44, v44, v46
v_add_f32 v45, v45, v47
v_add_f32 v40, v40, v44
v_add_f32 v41, v41, v45
v_fmac_f32 v24, v109, v40
v_fmac_f32 v26, v109, v41
v_add_f32 v48, v48, v50
v_add_f32 v49, v49, v51
v_add_f32 v52, v52, v54
v_add_f32 v53, v53, v55
v_add_f32 v48, v48, v52
v_add_f32 v49, v49, v53
v_fmac_f32 v24, v110, v48
v_fmac_f32 v26, v110, v49
v_add_f32 v56, v56, v58
v_add_f32 v57, v57, v59
v_add_f32 v60, v60, v62
v_add_f32 v61, v61, v63
v_add_f32 v56, v56, v60
v_add_f32 v57, v57, v61
v_fmac_f32 v24, v111, v56
v_fmac_f32 v26, v111, v57
v_mov_b32 v25, v10
v_mov_b32 v27, v10
s_lshl_b32 s9, s3, 3
s_add_u32 s10, s9, s4
s_mul_i32 s11, s10, 1152
s_add_u32 s11, s11, 397312
s_mul_i32 s15, s9, 1152
s_add_u32 s15, s15, 397312
buffer_store_dwordx4 v[24:27], v17, s[84:87], s11 offen sc1
v_mov_b32 v28, v104
v_mov_b32 v29, v10
v_mov_b32 v30, v105
v_mov_b32 v31, v10
v_mov_b32 v21, 0
buffer_store_dwordx4 v[28:31], v21, s[84:87], s11 offen offset:1024 sc1
s_mov_b32 s12, 0
L_go:
s_add_u32 s13, s15, 0
buffer_load_dwordx4 v[32:35], v17, s[84:87], s13 offen sc1
buffer_load_dwordx4 v[64:67], v21, s[84:87], s13 offen offset:1024 sc1
s_add_u32 s13, s15, 1152
buffer_load_dwordx4 v[36:39], v17, s[84:87], s13 offen sc1
buffer_load_dwordx4 v[68:71], v21, s[84:87], s13 offen offset:1024 sc1
s_add_u32 s13, s15, 2304
buffer_load_dwordx4 v[40:43], v17, s[84:87], s13 offen sc1
buffer_load_dwordx4 v[72:75], v21, s[84:87], s13 offen offset:1024 sc1
s_add_u32 s13, s15, 3456
buffer_load_dwordx4 v[44:47], v17, s[84:87], s13 offen sc1
buffer_load_dwordx4 v[76:79], v21, s[84:87], s13 offen offset:1024 sc1
s_add_u32 s13, s15, 4608
buffer_load_dwordx4 v[48:51], v17, s[84:87], s13 offen sc1
buffer_load_dwordx4 v[80:83], v21, s[84:87], s13 offen offset:1024 sc1
s_add_u32 s13, s15, 5760
buffer_load_dwordx4 v[52:55], v17, s[84:87], s13 offen sc1
buffer_load_dwordx4 v[84:87], v21, s[84:87], s13 offen offset:1024 sc1
s_add_u32 s13, s15, 6912
buffer_load_dwordx4 v[56:59], v17, s[84:87], s13 offen sc1
buffer_load_dwordx4 v[88:91], v21, s[84:87], s13 offen offset:1024 sc1
s_add_u32 s13, s15, 8064
buffer_load_dwordx4 v[60:63], v17, s[84:87], s13 offen sc1
buffer_load_dwordx4 v[92:95], v21, s[84:87], s13 offen offset:1024 sc1
s_waitcnt vmcnt(0)
v_mov_b32 v24, 0
v_xor_b32 v25, v10, v33
v_xor_b32 v26, v10, v35
v_or3_b32 v24, v24, v25, v26
v_xor_b32 v25, v10, v65
v_xor_b32 v26, v10, v67
v_or3_b32 v24, v24, v25, v26
v_xor_b32 v25, v10, v37
v_xor_b32 v26, v10, v39
v_or3_b32 v24, v24, v25, v26
v_xor_b32 v25, v10, v69
v_xor_b32 v26, v10, v71
v_or3_b32 v24, v24, v25, v26
v_xor_b32 v25, v10, v41
v_xor_b32 v26, v10, v43
v_or3_b32 v24, v24, v25, v26
v_xor_b32 v25, v10, v73
v_xor_b32 v26, v10, v75
v_or3_b32 v24, v24, v25, v26
v_xor_b32 v25, v10, v45
v_xor_b32 v26, v10, v47
v_or3_b32 v24, v24, v25, v26
v_xor_b32 v25, v10, v77
v_xor_b32 v26, v10, v79
v_or3_b32 v24, v24, v25, v26
v_xor_b32 v25, v10, v49
v_xor_b32 v26, v10, v51
v_or3_b32 v24, v24, v25, v26
v_xor_b32 v25, v10, v81
v_xor_b32 v26, v10, v83
v_or3_b32 v24, v24, v25, v26
v_xor_b32 v25, v10, v53
v_xor_b32 v26, v10, v55
v_or3_b32 v24, v24, v25, v26
v_xor_b32 v25, v10, v85
v_xor_b32 v26, v10, v87
v_or3_b32 v24, v24, v25, v26
v_xor_b32 v25, v10, v57
v_xor_b32 v26, v10, v59
v_or3_b32 v24, v24, v25, v26
v_xor_b32 v25, v10, v89
v_xor_b32 v26, v10, v91
v_or3_b32 v24, v24, v25, v26
v_xor_b32 v25, v10, v61
v_xor_b32 v26, v10, v63
v_or3_b32 v24, v24, v25, v26
v_xor_b32 v25, v10, v93
v_xor_b32 v26, v10, v95
v_or3_b32 v24, v24, v25, v26
v_cmp_ne_u32 vcc, 0, v24
s_add_u32 s12, s12, 1
s_cmp_gt_u32 s12, 200000
s_cbranch_scc1 L_go_done
s_cbranch_vccnz L_go
L_go_done:
v_max3_f32 v104, v64, v68, v72
v_max3_f32 v105, v76, v80, v84
v_max3_f32 v104, v104, v88, v92
v_max_f32 v104, v104, v105
v_sub_f32 v108, v64, v104
v_mul_f32 v108, 0x3fb8aa3b, v108
v_exp_f32 v108, v108
v_sub_f32 v109, v68, v104
v_mul_f32 v109, 0x3fb8aa3b, v109
v_exp_f32 v109, v109
v_sub_f32 v110, v72, v104
v_mul_f32 v110, 0x3fb8aa3b, v110
v_exp_f32 v110, v110
v_sub_f32 v111, v76, v104
v_mul_f32 v111, 0x3fb8aa3b, v111
v_exp_f32 v111, v111
v_sub_f32 v112, v80, v104
v_mul_f32 v112, 0x3fb8aa3b, v112
v_exp_f32 v112, v112
v_sub_f32 v113, v84, v104
v_mul_f32 v113, 0x3fb8aa3b, v113
v_exp_f32 v113, v113
v_sub_f32 v114, v88, v104
v_mul_f32 v114, 0x3fb8aa3b, v114
v_exp_f32 v114, v114
v_sub_f32 v115, v92, v104
v_mul_f32 v115, 0x3fb8aa3b, v115
v_exp_f32 v115, v115
s_nop 0
v_mov_b32 v105, 0
v_mov_b32 v24, 0
v_mov_b32 v25, 0
v_fmac_f32 v105, v108, v66
v_fmac_f32 v24, v108, v32
v_fmac_f32 v25, v108, v34
v_fmac_f32 v105, v109, v70
v_fmac_f32 v24, v109, v36
v_fmac_f32 v25, v109, v38
v_fmac_f32 v105, v110, v74
v_fmac_f32 v24, v110, v40
v_fmac_f32 v25, v110, v42
v_fmac_f32 v105, v111, v78
v_fmac_f32 v24, v111, v44
v_fmac_f32 v25, v111, v46
v_fmac_f32 v105, v112, v82
v_fmac_f32 v24, v112, v48
v_fmac_f32 v25, v112, v50
v_fmac_f32 v105, v113, v86
v_fmac_f32 v24, v113, v52
v_fmac_f32 v25, v113, v54
v_fmac_f32 v105, v114, v90
v_fmac_f32 v24, v114, v56
v_fmac_f32 v25, v114, v58
v_fmac_f32 v105, v115, v94
v_fmac_f32 v24, v115, v60
v_fmac_f32 v25, v115, v62
v_rcp_f32 v106, v105
s_nop 0
v_mul_f32 v24, v24, v106
v_mul_f32 v25, v25, v106
v_cvt_pk_bf16_f32 v24, v24, v24
v_lshlrev_b32 v24, 16, v24
v_cvt_pk_bf16_f32 v25, v25, v25
v_lshlrev_b32 v25, 16, v25
ds_write_b64 v19, v[24:25] offset:42304
s_waitcnt lgkmcnt(0)
s_barrier
s_barrier
v_cmp_gt_u32 vcc, 40, v1
v_subrev_u32 v22, 40, v1
s_nop 0
v_cndmask_b32 v22, v22, v1, vcc
v_lshlrev_b32 v23, 3, v22
ds_read_b64 v[32:33], v23 offset:43328
ds_read_b64 v[80:81], v23 offset:51008
ds_read_b64 v[34:35], v23 offset:43648
ds_read_b64 v[82:83], v23 offset:51328
ds_read_b64 v[36:37], v23 offset:43968
ds_read_b64 v[84:85], v23 offset:51648
ds_read_b64 v[38:39], v23 offset:44288
ds_read_b64 v[86:87], v23 offset:51968
ds_read_b64 v[40:41], v23 offset:44608
ds_read_b64 v[88:89], v23 offset:52288
ds_read_b64 v[42:43], v23 offset:44928
ds_read_b64 v[90:91], v23 offset:52608
ds_read_b64 v[44:45], v23 offset:45248
ds_read_b64 v[92:93], v23 offset:52928
ds_read_b64 v[46:47], v23 offset:45568
ds_read_b64 v[94:95], v23 offset:53248
ds_read_b64 v[48:49], v23 offset:45888
ds_read_b64 v[96:97], v23 offset:53568
ds_read_b64 v[50:51], v23 offset:46208
ds_read_b64 v[98:99], v23 offset:53888
ds_read_b64 v[52:53], v23 offset:46528
ds_read_b64 v[100:101], v23 offset:54208
ds_read_b64 v[54:55], v23 offset:46848
ds_read_b64 v[102:103], v23 offset:54528
ds_read_b64 v[56:57], v23 offset:47168
ds_read_b64 v[104:105], v23 offset:54848
ds_read_b64 v[58:59], v23 offset:47488
ds_read_b64 v[106:107], v23 offset:55168
ds_read_b64 v[60:61], v23 offset:47808
ds_read_b64 v[108:109], v23 offset:55488
ds_read_b64 v[62:63], v23 offset:48128
ds_read_b64 v[110:111], v23 offset:55808
ds_read_b64 v[64:65], v23 offset:48448
ds_read_b64 v[112:113], v23 offset:56128
ds_read_b64 v[66:67], v23 offset:48768
ds_read_b64 v[114:115], v23 offset:56448
ds_read_b64 v[68:69], v23 offset:49088
ds_read_b64 v[116:117], v23 offset:56768
ds_read_b64 v[70:71], v23 offset:49408
ds_read_b64 v[118:119], v23 offset:57088
ds_read_b64 v[72:73], v23 offset:49728
ds_read_b64 v[120:121], v23 offset:57408
ds_read_b64 v[74:75], v23 offset:50048
ds_read_b64 v[122:123], v23 offset:57728
ds_read_b64 v[76:77], v23 offset:50368
ds_read_b64 v[124:125], v23 offset:58048
ds_read_b64 v[78:79], v23 offset:50688
ds_read_b64 v[126:127], v23 offset:58368
s_waitcnt lgkmcnt(0)
v_add_f32 v32, v32, v34
v_add_f32 v33, v33, v35
v_add_f32 v32, v32, v36
v_add_f32 v33, v33, v37
v_add_f32 v32, v32, v38
v_add_f32 v33, v33, v39
v_add_f32 v32, v32, v40
v_add_f32 v33, v33, v41
v_add_f32 v32, v32, v42
v_add_f32 v33, v33, v43
v_add_f32 v32, v32, v44
v_add_f32 v33, v33, v45
v_add_f32 v32, v32, v46
v_add_f32 v33, v33, v47
v_add_f32 v32, v32, v48
v_add_f32 v33, v33, v49
v_add_f32 v32, v32, v50
v_add_f32 v33, v33, v51
v_add_f32 v32, v32, v52
v_add_f32 v33, v33, v53
v_add_f32 v32, v32, v54
v_add_f32 v33, v33, v55
v_add_f32 v32, v32, v56
v_add_f32 v33, v33, v57
v_add_f32 v32, v32, v58
v_add_f32 v33, v33, v59
v_add_f32 v32, v32, v60
v_add_f32 v33, v33, v61
v_add_f32 v32, v32, v62
v_add_f32 v33, v33, v63
v_add_f32 v32, v32, v64
v_add_f32 v33, v33, v65
v_add_f32 v32, v32, v66
v_add_f32 v33, v33, v67
v_add_f32 v32, v32, v68
v_add_f32 v33, v33, v69
v_add_f32 v32, v32, v70
v_add_f32 v33, v33, v71
v_add_f32 v32, v32, v72
v_add_f32 v33, v33, v73
v_add_f32 v32, v32, v74
v_add_f32 v33, v33, v75
v_add_f32 v32, v32, v76
v_add_f32 v33, v33, v77
v_add_f32 v32, v32, v78
v_add_f32 v33, v33, v79
v_add_f32 v80, v80, v82
v_add_f32 v81, v81, v83
v_add_f32 v80, v80, v84
v_add_f32 v81, v81, v85
v_add_f32 v80, v80, v86
v_add_f32 v81, v81, v87
v_add_f32 v80, v80, v88
v_add_f32 v81, v81, v89
v_add_f32 v80, v80, v90
v_add_f32 v81, v81, v91
v_add_f32 v80, v80, v92
v_add_f32 v81, v81, v93
v_add_f32 v80, v80, v94
v_add_f32 v81, v81, v95
v_add_f32 v80, v80, v96
v_add_f32 v81, v81, v97
v_add_f32 v80, v80, v98
v_add_f32 v81, v81, v99
v_add_f32 v80, v80, v100
v_add_f32 v81, v81, v101
v_add_f32 v80, v80, v102
v_add_f32 v81, v81, v103
v_add_f32 v80, v80, v104
v_add_f32 v81, v81, v105
v_add_f32 v80, v80, v106
v_add_f32 v81, v81, v107
v_add_f32 v80, v80, v108
v_add_f32 v81, v81, v109
v_add_f32 v80, v80, v110
v_add_f32 v81, v81, v111
v_add_f32 v80, v80, v112
v_add_f32 v81, v81, v113
v_add_f32 v80, v80, v114
v_add_f32 v81, v81, v115
v_add_f32 v80, v80, v116
v_add_f32 v81, v81, v117
v_add_f32 v80, v80, v118
v_add_f32 v81, v81, v119
v_add_f32 v80, v80, v120
v_add_f32 v81, v81, v121
v_add_f32 v80, v80, v122
v_add_f32 v81, v81, v123
v_add_f32 v80, v80, v124
v_add_f32 v81, v81, v125
v_add_f32 v80, v80, v126
v_add_f32 v81, v81, v127
v_lshlrev_b32 v23, 4, v22
s_lshl_b32 s9, s4, 5
s_add_u32 s9, s9, s3
s_mul_i32 s9, s9, 640
s_add_u32 s11, s9, 692224
s_add_u32 s13, s9, 856064
v_mov_b32 v24, v32
v_mov_b32 v25, v10
v_mov_b32 v26, v33
v_mov_b32 v27, v10
buffer_store_dwordx4 v[24:27], v23, s[84:87], s11 offen sc1
v_mov_b32 v28, v80
v_mov_b32 v29, v10
v_mov_b32 v30, v81
v_mov_b32 v31, v10
buffer_store_dwordx4 v[28:31], v23, s[84:87], s13 offen sc1
s_cmp_ge_u32 s3, 4
s_cbranch_scc1 L_end
s_mul_i32 s9, s4, 20480
s_mul_i32 s10, s3, 160
s_add_u32 s9, s9, s10
s_add_u32 s11, s9, 692224
s_add_u32 s13, s9, 856064
v_min_u32 v22, 5, v12
v_add_u32 v24, 0, v22
v_min_u32 v24, 31, v24
v_mul_u32_u24 v24, 640, v24
v_lshl_add_u32 v112, v13, 4, v24
v_add_u32 v24, 6, v22
v_min_u32 v24, 31, v24
v_mul_u32_u24 v24, 640, v24
v_lshl_add_u32 v113, v13, 4, v24
v_add_u32 v24, 12, v22
v_min_u32 v24, 31, v24
v_mul_u32_u24 v24, 640, v24
v_lshl_add_u32 v114, v13, 4, v24
v_add_u32 v24, 18, v22
v_min_u32 v24, 31, v24
v_mul_u32_u24 v24, 640, v24
v_lshl_add_u32 v115, v13, 4, v24
v_add_u32 v24, 24, v22
v_min_u32 v24, 31, v24
v_mul_u32_u24 v24, 640, v24
v_lshl_add_u32 v116, v13, 4, v24
v_add_u32 v24, 30, v22
v_min_u32 v24, 31, v24
v_mul_u32_u24 v24, 640, v24
v_lshl_add_u32 v117, v13, 4, v24
v_add_u32 v24, 0, v22
v_min_u32 v24, 26, v24
v_mul_u32_u24 v24, 640, v24
v_lshl_add_u32 v120, v13, 4, v24
v_add_u32 v24, 6, v22
v_min_u32 v24, 26, v24
v_mul_u32_u24 v24, 640, v24
v_lshl_add_u32 v121, v13, 4, v24
v_add_u32 v24, 12, v22
v_min_u32 v24, 26, v24
v_mul_u32_u24 v24, 640, v24
v_lshl_add_u32 v122, v13, 4, v24
v_add_u32 v24, 18, v22
v_min_u32 v24, 26, v24
v_mul_u32_u24 v24, 640, v24
v_lshl_add_u32 v123, v13, 4, v24
v_add_u32 v24, 24, v22
v_min_u32 v24, 26, v24
v_mul_u32_u24 v24, 640, v24
v_lshl_add_u32 v124, v13, 4, v24
s_mov_b32 s12, 0
L_gy:
buffer_load_dwordx4 v[32:35], v112, s[84:87], s11 offen sc1
buffer_load_dwordx4 v[36:39], v113, s[84:87], s11 offen sc1
buffer_load_dwordx4 v[40:43], v114, s[84:87], s11 offen sc1
buffer_load_dwordx4 v[44:47], v115, s[84:87], s11 offen sc1
buffer_load_dwordx4 v[48:51], v116, s[84:87], s11 offen sc1
buffer_load_dwordx4 v[52:55], v117, s[84:87], s11 offen sc1
buffer_load_dwordx4 v[64:67], v120, s[84:87], s13 offen sc1
buffer_load_dwordx4 v[68:71], v121, s[84:87], s13 offen sc1
buffer_load_dwordx4 v[72:75], v122, s[84:87], s13 offen sc1
buffer_load_dwordx4 v[76:79], v123, s[84:87], s13 offen sc1
buffer_load_dwordx4 v[80:83], v124, s[84:87], s13 offen sc1
s_waitcnt vmcnt(0)
v_mov_b32 v24, 0
v_xor_b32 v25, v10, v33
v_xor_b32 v26, v10, v35
v_or3_b32 v24, v24, v25, v26
v_xor_b32 v25, v10, v37
v_xor_b32 v26, v10, v39
v_or3_b32 v24, v24, v25, v26
v_xor_b32 v25, v10, v41
v_xor_b32 v26, v10, v43
v_or3_b32 v24, v24, v25, v26
v_xor_b32 v25, v10, v45
v_xor_b32 v26, v10, v47
v_or3_b32 v24, v24, v25, v26
v_xor_b32 v25, v10, v49
v_xor_b32 v26, v10, v51
v_or3_b32 v24, v24, v25, v26
v_xor_b32 v25, v10, v53
v_xor_b32 v26, v10, v55
v_or3_b32 v24, v24, v25, v26
v_xor_b32 v25, v10, v65
v_xor_b32 v26, v10, v67
v_or3_b32 v24, v24, v25, v26
v_xor_b32 v25, v10, v69
v_xor_b32 v26, v10, v71
v_or3_b32 v24, v24, v25, v26
v_xor_b32 v25, v10, v73
v_xor_b32 v26, v10, v75
v_or3_b32 v24, v24, v25, v26
v_xor_b32 v25, v10, v77
v_xor_b32 v26, v10, v79
v_or3_b32 v24, v24, v25, v26
v_xor_b32 v25, v10, v81
v_xor_b32 v26, v10, v83
v_or3_b32 v24, v24, v25, v26
v_cmp_ne_u32 vcc, 0, v24
s_add_u32 s12, s12, 1
s_cmp_gt_u32 s12, 200000
s_cbranch_scc1 L_gy_done
s_cbranch_vccnz L_gy
L_gy_done:
v_mov_b32 v96, 0
v_mov_b32 v97, 0
v_mov_b32 v98, 0
v_mov_b32 v99, 0
v_cmp_gt_u32 vcc, 6, v12
s_nop 1
v_cndmask_b32 v100, 0, v32, vcc
v_cndmask_b32 v101, 0, v34, vcc
v_add_f32 v96, v96, v100
v_add_f32 v97, v97, v101
v_cmp_gt_u32 vcc, 6, v12
s_nop 1
v_cndmask_b32 v100, 0, v36, vcc
v_cndmask_b32 v101, 0, v38, vcc
v_add_f32 v96, v96, v100
v_add_f32 v97, v97, v101
v_cmp_gt_u32 vcc, 6, v12
s_nop 1
v_cndmask_b32 v100, 0, v40, vcc
v_cndmask_b32 v101, 0, v42, vcc
v_add_f32 v96, v96, v100
v_add_f32 v97, v97, v101
v_cmp_gt_u32 vcc, 6, v12
s_nop 1
v_cndmask_b32 v100, 0, v44, vcc
v_cndmask_b32 v101, 0, v46, vcc
v_add_f32 v96, v96, v100
v_add_f32 v97, v97, v101
v_cmp_gt_u32 vcc, 6, v12
s_nop 1
v_cndmask_b32 v100, 0, v48, vcc
v_cndmask_b32 v101, 0, v50, vcc
v_add_f32 v96, v96, v100
v_add_f32 v97, v97, v101
v_cmp_gt_u32 vcc, 2, v12
s_nop 1
v_cndmask_b32 v100, 0, v52, vcc
v_cndmask_b32 v101, 0, v54, vcc
v_add_f32 v96, v96, v100
v_add_f32 v97, v97, v101
v_cmp_gt_u32 vcc, 6, v12
s_nop 1
v_cndmask_b32 v100, 0, v64, vcc
v_cndmask_b32 v101, 0, v66, vcc
v_add_f32 v98, v98, v100
v_add_f32 v99, v99, v101
v_cmp_gt_u32 vcc, 6, v12
s_nop 1
v_cndmask_b32 v100, 0, v68, vcc
v_cndmask_b32 v101, 0, v70, vcc
v_add_f32 v98, v98, v100
v_add_f32 v99, v99, v101
v_cmp_gt_u32 vcc, 6, v12
s_nop 1
v_cndmask_b32 v100, 0, v72, vcc
v_cndmask_b32 v101, 0, v74, vcc
v_add_f32 v98, v98, v100
v_add_f32 v99, v99, v101
v_cmp_gt_u32 vcc, 6, v12
s_nop 1
v_cndmask_b32 v100, 0, v76, vcc
v_cndmask_b32 v101, 0, v78, vcc
v_add_f32 v98, v98, v100
v_add_f32 v99, v99, v101
v_cmp_gt_u32 vcc, 3, v12
s_nop 1
v_cndmask_b32 v100, 0, v80, vcc
v_cndmask_b32 v101, 0, v82, vcc
v_add_f32 v98, v98, v100
v_add_f32 v99, v99, v101
v_mul_u32_u24 v24, 10, v22
v_add_u32 v24, v24, v13
v_lshlrev_b32 v24, 4, v24
v_cmp_gt_u32 vcc, 60, v1
s_and_saveexec_b64 s[8:9], vcc
ds_write_b128 v24, v[96:99] offset:58688
s_mov_b64 exec, s[8:9]
s_waitcnt lgkmcnt(0)
v_lshlrev_b32 v24, 4, v13
ds_read_b128 v[32:35], v24 offset:58688
ds_read_b128 v[36:39], v24 offset:58848
ds_read_b128 v[40:43], v24 offset:59008
ds_read_b128 v[44:47], v24 offset:59168
ds_read_b128 v[48:51], v24 offset:59328
ds_read_b128 v[52:55], v24 offset:59488
s_waitcnt lgkmcnt(0)
v_add_f32 v32, v32, v36
v_add_f32 v33, v33, v37
v_add_f32 v34, v34, v38
v_add_f32 v35, v35, v39
v_add_f32 v32, v32, v40
v_add_f32 v33, v33, v41
v_add_f32 v34, v34, v42
v_add_f32 v35, v35, v43
v_add_f32 v32, v32, v44
v_add_f32 v33, v33, v45
v_add_f32 v34, v34, v46
v_add_f32 v35, v35, v47
v_add_f32 v32, v32, v48
v_add_f32 v33, v33, v49
v_add_f32 v34, v34, v50
v_add_f32 v35, v35, v51
v_add_f32 v32, v32, v52
v_add_f32 v33, v33, v53
v_add_f32 v34, v34, v54
v_add_f32 v35, v35, v55
v_lshlrev_b32 v40, 16, v15
v_and_b32 v41, 0xffff0000, v15
v_lshlrev_b32 v42, 16, v16
v_and_b32 v43, 0xffff0000, v16
v_cvt_pk_bf16_f32 v32, v32, v32
v_lshlrev_b32 v32, 16, v32
v_add_f32 v32, v40, v32
v_cvt_pk_bf16_f32 v32, v32, v32
v_lshlrev_b32 v32, 16, v32
v_cvt_pk_bf16_f32 v34, v34, v34
v_lshlrev_b32 v34, 16, v34
v_add_f32 v34, v34, v42
v_cvt_pk_bf16_f32 v34, v34, v34
v_lshlrev_b32 v34, 16, v34
v_add_f32 v32, v32, v34
v_cvt_pk_bf16_f32 v33, v33, v33
v_lshlrev_b32 v33, 16, v33
v_add_f32 v33, v41, v33
v_cvt_pk_bf16_f32 v33, v33, v33
v_lshlrev_b32 v33, 16, v33
v_cvt_pk_bf16_f32 v35, v35, v35
v_lshlrev_b32 v35, 16, v35
v_add_f32 v35, v35, v43
v_cvt_pk_bf16_f32 v35, v35, v35
v_lshlrev_b32 v35, 16, v35
v_add_f32 v33, v33, v35
v_cvt_pk_bf16_f32 v44, v32, v33
v_cmp_gt_u32 vcc, 10, v1
s_and_saveexec_b64 s[8:9], vcc
buffer_store_dword v44, v14, s[80:83], s14 offen
s_mov_b64 exec, s[8:9]
s_cmp_lg_u32 s2, 0
s_cbranch_scc1 L_end
v_mov_b32 v45, s6
v_mov_b32 v4, 0
v_cmp_eq_u32 vcc, 0, v1
s_and_saveexec_b64 s[8:9], vcc
buffer_store_dword v45, v4, s[84:87], 0 offen offset:0
s_mov_b64 exec, s[8:9]
L_end:
s_endpgm
.section .rodata,"a"
.p2align 6
.amdhsa_kernel parallel_sum__sliding_block_cached__mixer_channel_mlp__decode_kernel
  .amdhsa_next_free_vgpr 168
  .amdhsa_next_free_sgpr 96
  .amdhsa_accum_offset 168
  .amdhsa_group_segment_fixed_size 0
  .amdhsa_kernarg_size 104
  .amdhsa_user_sgpr_count 2
  .amdhsa_user_sgpr_kernarg_segment_ptr 1
  .amdhsa_system_sgpr_workgroup_id_x 1
.end_amdhsa_kernel
```
